```python
import torch

def _softmax(x, axis=-1):
    return torch.softmax(x, dim=axis)
def _gelu(x):
    return torch.nn.functional.gelu(x, approximate="tanh")
def _silu(x):
    return torch.nn.functional.silu(x)
def _sigmoid(x):
    return torch.sigmoid(x)
def _layernorm(x, axis=-1, eps=1e-5):
    m = x.mean(dim=axis, keepdim=True)
    v = x.var(dim=axis, keepdim=True, unbiased=False)
    return (x - m) / torch.sqrt(v + eps)
def _scatter_add(tgt, idx, src, axis=0):
    return tgt.clone().index_add_(axis, idx, src)
def _segment_sum(src, seg, n):
    out = torch.zeros((n,) + src.shape[1:], dtype=src.dtype)
    return out.index_add_(0, seg, src)
def _pad(x, pw):
    flat = tuple(v for pair in reversed(pw) for v in pair)
    return torch.nn.functional.pad(x, flat)

kernel_name = 'concat_heads__softmax_full_mha__ssm_conv_h3__prompt'

def setup_inputs():

    _w = (lambda a: (lambda t: t.to(torch.bfloat16) if t.is_floating_point() else t)(torch.as_tensor(a)))
    def _A_setup():
        B, S, D = 1, 2048, 576
        return {
            "x": _w((lambda *s: torch.randn(*s, dtype=torch.bfloat16) * 0.2)(B, S, D)),
            "wqkv": _w((lambda *s: torch.randn(*s, dtype=torch.bfloat16) * 0.2)(D, 3 * D)),
            "wo": _w((lambda *s: torch.randn(*s, dtype=torch.bfloat16) * 0.05)(D, D)),
        }
    _A_in = _A_setup()

    def _B_setup():
        B, S, D = 1, 2048, 576
        ks = 4
        return {
            "q": _w((lambda *s: torch.randn(*s, dtype=torch.bfloat16) * 0.05)(B, S, D)),
            "k": _w((lambda *s: torch.randn(*s, dtype=torch.bfloat16) * 0.4)(B, S, D)),
            "v": _w((lambda *s: torch.randn(*s, dtype=torch.bfloat16) * 0.4)(B, S, D)),
            "shift_k": _w((lambda *s: torch.randn(*s, dtype=torch.bfloat16) * 0.4)(D, ks) * 0.5),
            "ssm_k": _w((lambda *s: torch.randn(*s, dtype=torch.bfloat16) * 1.6)(D, S) * (1.0 / S ** 0.5)),
            "ssm_D": _w((lambda *s: torch.randn(*s, dtype=torch.bfloat16) * 0.4)(D)),
        }
    _B_in = _B_setup()

    return {
        "A_x": _A_in["x"],
        "A_wqkv": _A_in["wqkv"],
        "A_wo": _A_in["wo"],
        "B_q": _B_in["q"],
        "B_k": _B_in["k"],
        "B_v": _B_in["v"],
        "B_shift_k": _B_in["shift_k"],
        "B_ssm_k": _B_in["ssm_k"],
        "B_ssm_D": _B_in["ssm_D"],
    }

def reference(A_x, A_wqkv, A_wo, B_q, B_k, B_v, B_shift_k, B_ssm_k, B_ssm_D):
    def _A_ref(x, wqkv, wo):
        B, S, D = x.shape
        H = 32; Dh = D // H
        qkv = (lambda x, *d: x.permute(*d))((x @ wqkv).reshape(B, S, 3, H, Dh), 2, 0, 3, 1, 4)
        q, k, v = qkv[0], qkv[1], qkv[2]
        scale = Dh ** -0.5
        scores = torch.einsum("bhqd,bhkd->bhqk", q, k) * scale
        p = _softmax(scores, axis=-1)
        o = torch.einsum("bhqk,bhkd->bhqd", p, v)
        return (lambda x, *d: x.permute(*d))(o, 0, 2, 1, 3).reshape(B, S, D) @ wo

    def _B_ref(q, k, v, shift_k, ssm_k, ssm_D):
        B, S, D = q.shape
        ks = shift_k.shape[-1]
        k_pad = _pad(k, ((0, 0), (ks - 1, 0), (0, 0)))
        k_shift = torch.zeros_like(k)
        for t in range(ks):
            k_shift = k_shift + k_pad[:, t:t + S, :] * shift_k[:, ks - 1 - t][None, None, :]
        kv = k_shift * v
        L = 2 * S
        kv_pad = _pad(kv, ((0, 0), (0, S), (0, 0)))
        kf_pad = _pad(ssm_k, ((0, 0), (0, S)))
        kv_f = (lambda x, axes=(-2,-1): torch.fft.rfft2(x.float(), dim=axes))(kv_pad[:, None, :, :], axes=(1, 2))
        kf_f = (lambda x, axes=(-2,-1): torch.fft.rfft2(x.float(), dim=axes))(kf_pad[:, None, :], axes=(1, 2))
        kf_f = (lambda x, *d: x.permute(*d))(kf_f, 1, 2, 0)
        y_f = kv_f * kf_f[None, :, :, :]
        y = (lambda x, s, axes=(-2,-1): torch.fft.irfft2(x, s=s, dim=axes).to(torch.bfloat16))(y_f, (1, L), axes=(1, 2))[:, 0, :S, :]
        y = y + kv * ssm_D[None, None, :]
        return q * y

    a = _A_ref(A_x, A_wqkv, A_wo)
    b = _B_ref(B_q, B_k, B_v, B_shift_k, B_ssm_k, B_ssm_D)
    return torch.concatenate([a, b], axis=-1)
```

```asm
; @launch grid=(256,1,1) block=(512,1,1) lds=163840
.amdgcn_target "amdgcn-amd-amdhsa--gfx950"
.text
.globl concat_heads__softmax_full_mha__ssm_conv_h3__prompt_kernel
.p2align 8
.type concat_heads__softmax_full_mha__ssm_conv_h3__prompt_kernel,@function
concat_heads__softmax_full_mha__ssm_conv_h3__prompt_kernel:
Lcode_begin:
    s_cmp_ge_u32 s2, 256
    s_cbranch_scc1 Lend
    s_load_dwordx16 s[64:79], s[0:1], 0
    s_load_dwordx8 s[80:87], s[0:1], 64
    v_lshrrev_b32 v1, 6, v0
    v_and_b32 v0, 63, v0
    v_readfirstlane_b32 s16, v1
    s_lshl_b32 s3, s16, 2
    s_add_u32 s3, s3, 161024
    s_and_b32 s94, s3, 4294967280
    s_cmp_ge_u32 s2, 224
    s_cbranch_scc1 Ls1
    s_and_b32 s17, s2, 7
    s_lshr_b32 s18, s2, 3
    s_and_b32 s19, s17, 3
    s_lshl_b32 s19, s19, 2
    s_and_b32 s20, s18, 3
    s_add_u32 s19, s19, s20
    s_lshr_b32 s21, s17, 2
    s_mul_i32 s21, s21, 7
    s_lshr_b32 s22, s18, 2
    s_add_u32 s21, s21, s22
    s_cmp_lt_u32 s16, 4
    s_cbranch_scc1 Lg_compute
    s_and_b32 s23, s16, 3
    s_mul_i32 s24, s20, 5
    s_lshr_b32 s24, s24, 1
    s_add_u32 s24, s24, s22
    s_cmp_ge_u32 s24, 9
    s_cselect_b32 s25, 9, 0
    s_sub_u32 s24, s24, s25
    s_lshl_b32 s25, s19, 7
    s_lshl_b32 s26, s23, 5
    s_add_u32 s25, s25, s26
    s_mul_i32 s25, s25, 1152
    s_lshl_b32 s26, s24, 7
    s_add_u32 s40, s25, s26
    s_lshl_b32 s25, s24, 2
    s_add_u32 s25, s25, s23
    s_mul_i32 s25, s25, 55296
    s_lshl_b32 s26, s21, 8
    s_add_u32 s41, s25, s26
    s_lshl_b32 s42, s23, 12
    v_lshrrev_b32 v1, 3, v0
    v_mul_u32_u24 v1, 1152, v1
    v_lshrrev_b32 v2, 4, v0
    v_and_b32 v3, 7, v0
    v_xor_b32 v3, v3, v2
    v_lshl_add_u32 v8, v3, 4, v1
    v_xor_b32 v3, 4, v3
    v_lshl_add_u32 v9, v3, 4, v1
    v_mul_u32_u24 v1, 3456, v2
    v_and_b32 v3, 15, v0
    v_lshlrev_b32 v2, 2, v2
    v_xor_b32 v3, v3, v2
    v_lshl_add_u32 v10, v3, 4, v1
    s_mov_b32 s95, 0
    s_setprio 0
    s_waitcnt lgkmcnt(0)
    s_mov_b32 s8, s64
    s_mov_b32 s9, s65
    s_mov_b32 s10, 2359296
    s_mov_b32 s11, 0x20000
    s_mov_b32 s44, s66
    s_mov_b32 s45, s67
    s_mov_b32 s46, 1990656
    s_mov_b32 s47, 0x20000
    s_mov_b32 s31, 0
Lld:
    s_cmp_lt_u32 s31, 2
    s_cbranch_scc1 Lld_go
    s_waitcnt vmcnt(8)
    s_barrier
Lld_go:
    s_mov_b32 m0, s42
    s_add_u32 s26, s40, 8192
    buffer_load_dwordx4 v8, s[8:11], s40 offen lds
    s_add_u32 s27, s40, 16384
    buffer_load_dwordx4 v9, s[8:11], s26 offen offset:1024 lds
    s_add_u32 s26, s40, 24576
    buffer_load_dwordx4 v8, s[8:11], s27 offen offset:2048 lds
    s_add_u32 s28, s42, 16384
    buffer_load_dwordx4 v9, s[8:11], s26 offen offset:3072 lds
    s_mov_b32 m0, s28
    s_add_u32 s26, s41, 12800
    buffer_load_dwordx4 v10, s[44:47], s41 offen lds
    s_add_u32 s27, s41, 25600
    buffer_load_dwordx4 v10, s[44:47], s26 offen offset:1024 lds
    s_add_u32 s26, s41, 38400
    buffer_load_dwordx4 v10, s[44:47], s27 offen offset:2048 lds
    s_add_u32 s40, s40, 128
    buffer_load_dwordx4 v10, s[44:47], s26 offen offset:3072 lds
    s_add_u32 s41, s41, 221184
    s_add_u32 s24, s24, 1
    s_cmp_eq_u32 s24, 9
    s_cselect_b32 s26, 1152, 0
    s_cselect_b32 s27, 1990656, 0
    s_sub_u32 s40, s40, s26
    s_sub_u32 s41, s41, s27
    s_add_u32 s42, s42, 32768
    s_cmp_ge_u32 s42, 131072
    s_cselect_b32 s26, 131072, 0
    s_sub_u32 s42, s42, s26
Lk1:
    s_add_u32 s31, s31, 1
    s_cmp_lt_u32 s31, 9
    s_cbranch_scc1 Lld
    s_waitcnt vmcnt(8)
    s_barrier
    s_mov_b32 s12, s86
    s_mov_b32 s13, s87
    s_mov_b32 s14, 22028288
    s_mov_b32 s15, 0x20000
    s_waitcnt vmcnt(0)
    s_barrier
    s_branch Lh_start
Lg_compute:
    s_and_b32 s23, s16, 1
    s_lshr_b32 s24, s16, 1
    v_and_b32 v5, 31, v0
    v_lshrrev_b32 v6, 5, v0
    s_lshl_b32 s25, s23, 13
    v_lshlrev_b32 v1, 7, v5
    v_add_u32 v1, s25, v1
    v_bfe_u32 v2, v0, 1, 3
    v_xor_b32 v2, v2, v6
    v_xor_b32 v3, 0, v2
    v_lshl_add_u32 v8, v3, 4, v1
    v_xor_b32 v3, 2, v2
    v_lshl_add_u32 v9, v3, 4, v1
    v_xor_b32 v3, 4, v2
    v_lshl_add_u32 v10, v3, 4, v1
    v_xor_b32 v3, 6, v2
    v_lshl_add_u32 v11, v3, 4, v1
    v_bfe_u32 v1, v0, 2, 2
    v_lshl_add_u32 v2, v6, 3, v1
    v_lshlrev_b32 v2, 8, v2
    v_bfe_u32 v3, v0, 4, 1
    v_lshl_add_u32 v2, v3, 5, v2
    v_and_b32 v3, 3, v0
    v_lshl_add_u32 v2, v3, 3, v2
    s_lshl_b32 s25, s24, 1
    v_xor_b32 v3, s25, v1
    v_lshl_add_u32 v12, v3, 6, v2
    v_xor_b32 v3, 1, v3
    v_lshl_add_u32 v13, v3, 6, v2
    s_mov_b32 s30, 0
    s_waitcnt lgkmcnt(0)
    s_mov_b32 s12, s86
    s_mov_b32 s13, s87
    s_mov_b32 s14, 22028288
    s_mov_b32 s15, 0x20000
    s_and_b32 s25, s16, 3
    s_lshl_b32 s25, s25, 7
    s_add_u32 s25, s25, 4294967282
    v_add_u32 v144, s25, v0
    v_mul_u32_u24 v145, 1821, v144
    v_lshrrev_b32 v145, 16, v145
    v_mul_u32_u24 v145, 36, v145
    v_cmp_eq_u32 s[34:35], v145, v144
    v_cmp_gt_u32 vcc, 288, v144
    v_mov_b32 v145, 0x3f803f80
    v_lshlrev_b32 v144, 4, v144
    s_and_b64 vcc, vcc, s[34:35]
    v_add_u32 v144, 155872, v144
    v_cndmask_b32 v140, 0, v145, vcc
    v_cndmask_b32 v141, 0, v145, vcc
    v_cndmask_b32 v142, 0, v145, vcc
    v_cndmask_b32 v143, 0, v145, vcc
    ds_write_b128 v144, v[140:143]
    s_and_b32 s25, s16, 3
    s_lshl_b32 s25, s25, 7
    s_add_u32 s25, s25, 50
    v_add_u32 v144, s25, v0
    v_mul_u32_u24 v145, 1821, v144
    v_lshrrev_b32 v145, 16, v145
    v_mul_u32_u24 v145, 36, v145
    v_cmp_eq_u32 s[34:35], v145, v144
    v_cmp_gt_u32 vcc, 288, v144
    v_mov_b32 v145, 0x3f803f80
    v_lshlrev_b32 v144, 4, v144
    s_and_b64 vcc, vcc, s[34:35]
    v_add_u32 v144, 155872, v144
    v_cndmask_b32 v140, 0, v145, vcc
    v_cndmask_b32 v141, 0, v145, vcc
    v_cndmask_b32 v142, 0, v145, vcc
    v_cndmask_b32 v143, 0, v145, vcc
    ds_write_b128 v144, v[140:143]
    v_add_u32 v14, s30, v8
    v_add_u32 v15, s30, v9
    v_add_u32 v16, s30, v10
    v_add_u32 v17, s30, v11
    v_add_u32 v18, s30, v12
    v_add_u32 v19, s30, v13
    v_mov_b32 v68, 0
    v_mov_b32 v69, 0
    v_mov_b32 v70, 0
    v_mov_b32 v71, 0
    v_mov_b32 v72, 0
    v_mov_b32 v73, 0
    v_mov_b32 v74, 0
    v_mov_b32 v75, 0
    v_mov_b32 v76, 0
    v_mov_b32 v77, 0
    v_mov_b32 v78, 0
    v_mov_b32 v79, 0
    v_mov_b32 v80, 0
    v_mov_b32 v81, 0
    v_mov_b32 v82, 0
    v_mov_b32 v83, 0
    v_mov_b32 v84, 0
    v_mov_b32 v85, 0
    v_mov_b32 v86, 0
    v_mov_b32 v87, 0
    v_mov_b32 v88, 0
    v_mov_b32 v89, 0
    v_mov_b32 v90, 0
    v_mov_b32 v91, 0
    v_mov_b32 v92, 0
    v_mov_b32 v93, 0
    v_mov_b32 v94, 0
    v_mov_b32 v95, 0
    v_mov_b32 v96, 0
    v_mov_b32 v97, 0
    v_mov_b32 v98, 0
    v_mov_b32 v99, 0
    v_mov_b32 v100, 0
    v_mov_b32 v101, 0
    v_mov_b32 v102, 0
    v_mov_b32 v103, 0
    v_mov_b32 v104, 0
    v_mov_b32 v105, 0
    v_mov_b32 v106, 0
    v_mov_b32 v107, 0
    v_mov_b32 v108, 0
    v_mov_b32 v109, 0
    v_mov_b32 v110, 0
    v_mov_b32 v111, 0
    v_mov_b32 v112, 0
    v_mov_b32 v113, 0
    v_mov_b32 v114, 0
    v_mov_b32 v115, 0
    v_mov_b32 v116, 0
    v_mov_b32 v117, 0
    v_mov_b32 v118, 0
    v_mov_b32 v119, 0
    v_mov_b32 v120, 0
    v_mov_b32 v121, 0
    v_mov_b32 v122, 0
    v_mov_b32 v123, 0
    v_mov_b32 v124, 0
    v_mov_b32 v125, 0
    v_mov_b32 v126, 0
    v_mov_b32 v127, 0
    v_mov_b32 v128, 0
    v_mov_b32 v129, 0
    v_mov_b32 v130, 0
    v_mov_b32 v131, 0
    s_lshl_b32 s25, s21, 7
    s_sub_u32 s25, 71, s25
    v_mul_u32_u24 v1, 72, v0
    v_add_u32 v1, s25, v1
    v_add_u32 v2, 576, v1
    v_add_u32 v3, 1152, v1
    v_min_u32 v1, v1, v2
    v_min_u32 v1, v1, v3
    v_cmp_gt_u32 vcc, 199, v1
    s_nop 3
    s_and_b64 s[36:37], vcc, 0xff
    s_lshl_b32 s26, s19, 2
    s_lshl_b32 s27, s23, 1
    s_add_u32 s26, s26, s27
    s_waitcnt lgkmcnt(0)
    s_cmp_ge_u32 s21, 9
    s_cbranch_scc1 Lg_vtype
    s_lshl_b32 s27, s21, 5
    s_lshl_b32 s28, s24, 4
    s_add_u32 s27, s27, s28
    v_add_u32 v1, s27, v6
    s_lshl_b32 s28, s26, 10
    s_lshl_b32 s29, s26, 8
    s_add_u32 s29, s29, 139264
    v_lshlrev_b32 v5, 3, v5
    v_add_u32 v132, s29, v5
    v_add_u32 v133, s28, v5
    v_add_u32 v134, 154368, v133
    v_mov_b32 v135, 256
    v_mov_b32 v136, 1024
    s_mov_b32 s32, 294912
    v_add_u32 v2, 0, v1
    v_mul_u32_u24 v3, 7282, v2
    v_lshrrev_b32 v3, 16, v3
    v_mul_u32_u24 v4, 9, v3
    v_sub_u32 v2, v2, v4
    v_cmp_lt_u32 vcc, 4, v2
    v_cmp_eq_u32 s[34:35], 4, v2
    v_mul_u32_u24 v3, s32, v3
    v_cndmask_b32 v4, v133, v134, vcc
    v_lshl_add_u32 v4, v2, 8, v4
    v_cndmask_b32 v4, v4, v132, s[34:35]
    v_cndmask_b32 v2, v136, v135, s[34:35]
    v_add_u32 v20, v3, v4
    v_add_u32 v28, v20, v2
    v_add_u32 v2, 2, v1
    v_mul_u32_u24 v3, 7282, v2
    v_lshrrev_b32 v3, 16, v3
    v_mul_u32_u24 v4, 9, v3
    v_sub_u32 v2, v2, v4
    v_cmp_lt_u32 vcc, 4, v2
    v_cmp_eq_u32 s[34:35], 4, v2
    v_mul_u32_u24 v3, s32, v3
    v_cndmask_b32 v4, v133, v134, vcc
    v_lshl_add_u32 v4, v2, 8, v4
    v_cndmask_b32 v4, v4, v132, s[34:35]
    v_cndmask_b32 v2, v136, v135, s[34:35]
    v_add_u32 v21, v3, v4
    v_add_u32 v29, v21, v2
    v_add_u32 v2, 4, v1
    v_mul_u32_u24 v3, 7282, v2
    v_lshrrev_b32 v3, 16, v3
    v_mul_u32_u24 v4, 9, v3
    v_sub_u32 v2, v2, v4
    v_cmp_lt_u32 vcc, 4, v2
    v_cmp_eq_u32 s[34:35], 4, v2
    v_mul_u32_u24 v3, s32, v3
    v_cndmask_b32 v4, v133, v134, vcc
    v_lshl_add_u32 v4, v2, 8, v4
    v_cndmask_b32 v4, v4, v132, s[34:35]
    v_cndmask_b32 v2, v136, v135, s[34:35]
    v_add_u32 v22, v3, v4
    v_add_u32 v30, v22, v2
    v_add_u32 v2, 6, v1
    v_mul_u32_u24 v3, 7282, v2
    v_lshrrev_b32 v3, 16, v3
    v_mul_u32_u24 v4, 9, v3
    v_sub_u32 v2, v2, v4
    v_cmp_lt_u32 vcc, 4, v2
    v_cmp_eq_u32 s[34:35], 4, v2
    v_mul_u32_u24 v3, s32, v3
    v_cndmask_b32 v4, v133, v134, vcc
    v_lshl_add_u32 v4, v2, 8, v4
    v_cndmask_b32 v4, v4, v132, s[34:35]
    v_cndmask_b32 v2, v136, v135, s[34:35]
    v_add_u32 v23, v3, v4
    v_add_u32 v31, v23, v2
    v_add_u32 v2, 8, v1
    v_mul_u32_u24 v3, 7282, v2
    v_lshrrev_b32 v3, 16, v3
    v_mul_u32_u24 v4, 9, v3
    v_sub_u32 v2, v2, v4
    v_cmp_lt_u32 vcc, 4, v2
    v_cmp_eq_u32 s[34:35], 4, v2
    v_mul_u32_u24 v3, s32, v3
    v_cndmask_b32 v4, v133, v134, vcc
    v_lshl_add_u32 v4, v2, 8, v4
    v_cndmask_b32 v4, v4, v132, s[34:35]
    v_cndmask_b32 v2, v136, v135, s[34:35]
    v_add_u32 v24, v3, v4
    v_add_u32 v32, v24, v2
    v_add_u32 v2, 10, v1
    v_mul_u32_u24 v3, 7282, v2
    v_lshrrev_b32 v3, 16, v3
    v_mul_u32_u24 v4, 9, v3
    v_sub_u32 v2, v2, v4
    v_cmp_lt_u32 vcc, 4, v2
    v_cmp_eq_u32 s[34:35], 4, v2
    v_mul_u32_u24 v3, s32, v3
    v_cndmask_b32 v4, v133, v134, vcc
    v_lshl_add_u32 v4, v2, 8, v4
    v_cndmask_b32 v4, v4, v132, s[34:35]
    v_cndmask_b32 v2, v136, v135, s[34:35]
    v_add_u32 v25, v3, v4
    v_add_u32 v33, v25, v2
    v_add_u32 v2, 12, v1
    v_mul_u32_u24 v3, 7282, v2
    v_lshrrev_b32 v3, 16, v3
    v_mul_u32_u24 v4, 9, v3
    v_sub_u32 v2, v2, v4
    v_cmp_lt_u32 vcc, 4, v2
    v_cmp_eq_u32 s[34:35], 4, v2
    v_mul_u32_u24 v3, s32, v3
    v_cndmask_b32 v4, v133, v134, vcc
    v_lshl_add_u32 v4, v2, 8, v4
    v_cndmask_b32 v4, v4, v132, s[34:35]
    v_cndmask_b32 v2, v136, v135, s[34:35]
    v_add_u32 v26, v3, v4
    v_add_u32 v34, v26, v2
    v_add_u32 v2, 14, v1
    v_mul_u32_u24 v3, 7282, v2
    v_lshrrev_b32 v3, 16, v3
    v_mul_u32_u24 v4, 9, v3
    v_sub_u32 v2, v2, v4
    v_cmp_lt_u32 vcc, 4, v2
    v_cmp_eq_u32 s[34:35], 4, v2
    v_mul_u32_u24 v3, s32, v3
    v_cndmask_b32 v4, v133, v134, vcc
    v_lshl_add_u32 v4, v2, 8, v4
    v_cndmask_b32 v4, v4, v132, s[34:35]
    v_cndmask_b32 v2, v136, v135, s[34:35]
    v_add_u32 v27, v3, v4
    v_add_u32 v35, v27, v2
    s_lshl_b32 s27, s21, 2
    s_lshl_b32 s28, s24, 1
    s_add_u32 s27, s27, s28
    s_cmp_lt_u32 s27, 18
    s_cselect_b32 s28, 1051597459, 1.0
    s_mov_b32 s29, s28
    s_mov_b32 s31, 7
    s_barrier
    ds_read_b128 v[36:39], v14
    ds_read_b64_tr_b16 v[44:45], v18 offset:16384
    ds_read_b64_tr_b16 v[46:47], v18 offset:17408
    ds_read_b64_tr_b16 v[48:49], v19 offset:16384
    ds_read_b64_tr_b16 v[50:51], v19 offset:17408
    ds_read_b128 v[40:43], v14 offset:4096
.p2align 6
Lg_qk:
    s_waitcnt lgkmcnt(3)
    v_mfma_f32_32x32x16_bf16 v[68:83], v[44:47], v[36:39], v[68:83]
    ds_read_b128 v[52:55], v15
    ds_read_b64_tr_b16 v[60:61], v18 offset:20480
    ds_read_b64_tr_b16 v[62:63], v18 offset:21504
    s_waitcnt lgkmcnt(4)
    v_mfma_f32_32x32x16_bf16 v[84:99], v[48:51], v[36:39], v[84:99]
    ds_read_b64_tr_b16 v[64:65], v19 offset:20480
    ds_read_b64_tr_b16 v[66:67], v19 offset:21504
    ds_read_b128 v[56:59], v15 offset:4096
    s_waitcnt lgkmcnt(6)
    v_mfma_f32_32x32x16_bf16 v[100:115], v[44:47], v[40:43], v[100:115]
    v_mfma_f32_32x32x16_bf16 v[116:131], v[48:51], v[40:43], v[116:131]
    s_waitcnt lgkmcnt(3)
    v_mfma_f32_32x32x16_bf16 v[68:83], v[60:63], v[52:55], v[68:83]
    ds_read_b128 v[36:39], v16
    ds_read_b64_tr_b16 v[44:45], v18 offset:24576
    ds_read_b64_tr_b16 v[46:47], v18 offset:25600
    s_waitcnt lgkmcnt(4)
    v_mfma_f32_32x32x16_bf16 v[84:99], v[64:67], v[52:55], v[84:99]
    ds_read_b64_tr_b16 v[48:49], v19 offset:24576
    ds_read_b64_tr_b16 v[50:51], v19 offset:25600
    ds_read_b128 v[40:43], v16 offset:4096
    s_waitcnt lgkmcnt(6)
    v_mfma_f32_32x32x16_bf16 v[100:115], v[60:63], v[56:59], v[100:115]
    v_mfma_f32_32x32x16_bf16 v[116:131], v[64:67], v[56:59], v[116:131]
    s_waitcnt lgkmcnt(3)
    v_mfma_f32_32x32x16_bf16 v[68:83], v[44:47], v[36:39], v[68:83]
    ds_read_b128 v[52:55], v17
    ds_read_b64_tr_b16 v[60:61], v18 offset:28672
    ds_read_b64_tr_b16 v[62:63], v18 offset:29696
    s_waitcnt lgkmcnt(4)
    v_mfma_f32_32x32x16_bf16 v[84:99], v[48:51], v[36:39], v[84:99]
    ds_read_b64_tr_b16 v[64:65], v19 offset:28672
    ds_read_b64_tr_b16 v[66:67], v19 offset:29696
    ds_read_b128 v[56:59], v17 offset:4096
    s_waitcnt lgkmcnt(6)
    v_mfma_f32_32x32x16_bf16 v[100:115], v[44:47], v[40:43], v[100:115]
    s_add_u32 s30, s30, 32768
    s_and_b32 s30, s30, 131071
    s_sub_u32 s31, s31, 1
    s_cmp_eq_u32 s31, 0
    v_mfma_f32_32x32x16_bf16 v[116:131], v[48:51], v[40:43], v[116:131]
    s_barrier
    v_add_u32 v14, s30, v8
    v_add_u32 v15, s30, v9
    v_add_u32 v16, s30, v10
    v_add_u32 v17, s30, v11
    v_add_u32 v18, s30, v12
    v_add_u32 v19, s30, v13
    s_waitcnt lgkmcnt(3)
    v_mfma_f32_32x32x16_bf16 v[68:83], v[60:63], v[52:55], v[68:83]
    ds_read_b128 v[36:39], v14
    ds_read_b64_tr_b16 v[44:45], v18 offset:16384
    ds_read_b64_tr_b16 v[46:47], v18 offset:17408
    s_waitcnt lgkmcnt(4)
    v_mfma_f32_32x32x16_bf16 v[84:99], v[64:67], v[52:55], v[84:99]
    ds_read_b64_tr_b16 v[48:49], v19 offset:16384
    ds_read_b64_tr_b16 v[50:51], v19 offset:17408
    ds_read_b128 v[40:43], v14 offset:4096
    s_waitcnt lgkmcnt(6)
    v_mfma_f32_32x32x16_bf16 v[100:115], v[60:63], v[56:59], v[100:115]
    v_mfma_f32_32x32x16_bf16 v[116:131], v[64:67], v[56:59], v[116:131]
    s_cbranch_scc0 Lg_qk
    ds_read_b128 v[52:55], v15
    ds_read_b64_tr_b16 v[60:61], v18 offset:20480
    ds_read_b64_tr_b16 v[62:63], v18 offset:21504
    ds_read_b128 v[148:151], v16
    ds_read_b64_tr_b16 v[156:157], v18 offset:24576
    ds_read_b64_tr_b16 v[158:159], v18 offset:25600
    ds_read_b128 v[164:167], v17
    ds_read_b64_tr_b16 v[172:173], v18 offset:28672
    ds_read_b64_tr_b16 v[174:175], v18 offset:29696
    s_waitcnt lgkmcnt(9)
    v_mfma_f32_32x32x16_bf16 v[68:83], v[44:47], v[36:39], v[68:83]
    ds_read_b64_tr_b16 v[64:65], v19 offset:20480
    ds_read_b64_tr_b16 v[66:67], v19 offset:21504
    s_waitcnt lgkmcnt(8)
    v_mfma_f32_32x32x16_bf16 v[68:83], v[60:63], v[52:55], v[68:83]
    ds_read_b64_tr_b16 v[160:161], v19 offset:24576
    ds_read_b64_tr_b16 v[162:163], v19 offset:25600
    s_waitcnt lgkmcnt(7)
    v_mfma_f32_32x32x16_bf16 v[68:83], v[156:159], v[148:151], v[68:83]
    ds_read_b64_tr_b16 v[176:177], v19 offset:28672
    ds_read_b64_tr_b16 v[178:179], v19 offset:29696
    s_waitcnt lgkmcnt(6)
    v_mfma_f32_32x32x16_bf16 v[68:83], v[172:175], v[164:167], v[68:83]
    ds_read_b128 v[56:59], v15 offset:4096
    ds_read_b128 v[152:155], v16 offset:4096
    ds_read_b128 v[168:171], v17 offset:4096
    s_add_u32 s30, s30, 32768
    s_and_b32 s30, s30, 131071
    s_barrier
    v_add_u32 v14, s30, v8
    v_add_u32 v15, s30, v9
    v_add_u32 v16, s30, v10
    v_add_u32 v17, s30, v11
    v_add_u32 v18, s30, v12
    v_add_u32 v19, s30, v13
    s_waitcnt lgkmcnt(3)
    v_mfma_f32_32x32x16_bf16 v[84:99], v[48:51], v[36:39], v[84:99]
    ds_read_b128 v[180:183], v14
    ds_read_b64_tr_b16 v[188:189], v18 offset:16384
    ds_read_b64_tr_b16 v[190:191], v18 offset:17408
    v_mfma_f32_32x32x16_bf16 v[84:99], v[64:67], v[52:55], v[84:99]
    ds_read_b128 v[196:199], v15
    ds_read_b64_tr_b16 v[204:205], v18 offset:20480
    ds_read_b64_tr_b16 v[206:207], v18 offset:21504
    v_mfma_f32_32x32x16_bf16 v[84:99], v[160:163], v[148:151], v[84:99]
    ds_read_b128 v[216:219], v16
    ds_read_b64_tr_b16 v[224:225], v18 offset:24576
    ds_read_b64_tr_b16 v[226:227], v18 offset:25600
    v_mfma_f32_32x32x16_bf16 v[84:99], v[176:179], v[164:167], v[84:99]
    ds_read_b128 v[232:235], v17
    ds_read_b64_tr_b16 v[240:241], v18 offset:28672
    ds_read_b64_tr_b16 v[242:243], v18 offset:29696
    s_waitcnt lgkmcnt(9)
    v_mfma_f32_32x32x16_bf16 v[68:83], v[188:191], v[180:183], v[68:83]
    ds_read_b64_tr_b16 v[192:193], v19 offset:16384
    ds_read_b64_tr_b16 v[194:195], v19 offset:17408
    s_waitcnt lgkmcnt(8)
    v_mfma_f32_32x32x16_bf16 v[68:83], v[204:207], v[196:199], v[68:83]
    ds_read_b64_tr_b16 v[208:209], v19 offset:20480
    ds_read_b64_tr_b16 v[210:211], v19 offset:21504
    s_waitcnt lgkmcnt(7)
    v_mfma_f32_32x32x16_bf16 v[68:83], v[224:227], v[216:219], v[68:83]
    ds_read_b64_tr_b16 v[228:229], v19 offset:24576
    ds_read_b64_tr_b16 v[230:231], v19 offset:25600
    s_waitcnt lgkmcnt(6)
    v_mfma_f32_32x32x16_bf16 v[68:83], v[240:243], v[232:235], v[68:83]
    ds_read_b64_tr_b16 v[244:245], v19 offset:28672
    ds_read_b64_tr_b16 v[246:247], v19 offset:29696
    s_waitcnt lgkmcnt(0)
    v_mfma_f32_32x32x16_bf16 v[84:99], v[192:195], v[180:183], v[84:99]
    ds_read_b128 v[184:187], v14 offset:4096
    ds_read_b128 v[200:203], v15 offset:4096
    ds_read_b128 v[220:223], v16 offset:4096
    ds_read_b128 v[236:239], v17 offset:4096
    s_nop 3
    v_mfma_f32_32x32x16_bf16 v[84:99], v[208:211], v[196:199], v[84:99]
    v_mul_f32 v68, s28, v68
    v_mul_f32 v69, s28, v69
    v_mul_f32 v70, s28, v70
    v_mul_f32 v71, s28, v71
    v_cvt_pk_bf16_f32 v132, v68, v69
    v_cvt_pk_bf16_f32 v133, v70, v71
    buffer_store_dwordx2 v[132:133], v20, s[12:15], 0 offen sc1
    v_mfma_f32_32x32x16_bf16 v[84:99], v[228:231], v[216:219], v[84:99]
    v_mul_f32 v72, s28, v72
    v_mul_f32 v73, s28, v73
    v_mul_f32 v74, s28, v74
    v_mul_f32 v75, s28, v75
    v_cvt_pk_bf16_f32 v134, v72, v73
    v_cvt_pk_bf16_f32 v135, v74, v75
    buffer_store_dwordx2 v[134:135], v21, s[12:15], 0 offen sc1
    v_mfma_f32_32x32x16_bf16 v[84:99], v[244:247], v[232:235], v[84:99]
    v_mul_f32 v76, s28, v76
    v_mul_f32 v77, s28, v77
    v_mul_f32 v78, s28, v78
    v_mul_f32 v79, s28, v79
    v_cvt_pk_bf16_f32 v136, v76, v77
    v_cvt_pk_bf16_f32 v137, v78, v79
    buffer_store_dwordx2 v[136:137], v22, s[12:15], 0 offen sc1
    v_mfma_f32_32x32x16_bf16 v[100:115], v[44:47], v[40:43], v[100:115]
    s_nop 7
    v_mul_f32 v80, s28, v80
    v_mul_f32 v81, s28, v81
    v_mul_f32 v82, s28, v82
    v_mul_f32 v83, s28, v83
    v_cvt_pk_bf16_f32 v138, v80, v81
    v_cvt_pk_bf16_f32 v139, v82, v83
    buffer_store_dwordx2 v[138:139], v23, s[12:15], 0 offen sc1
    v_mfma_f32_32x32x16_bf16 v[100:115], v[60:63], v[56:59], v[100:115]
    s_nop 1
    v_mul_f32 v84, s28, v84
    v_mul_f32 v85, s28, v85
    v_mul_f32 v86, s28, v86
    v_mul_f32 v87, s28, v87
    v_cvt_pk_bf16_f32 v140, v84, v85
    v_cvt_pk_bf16_f32 v141, v86, v87
    buffer_store_dwordx2 v[140:141], v24, s[12:15], 0 offen sc1
    v_mfma_f32_32x32x16_bf16 v[100:115], v[156:159], v[152:155], v[100:115]
    v_mul_f32 v88, s28, v88
    v_mul_f32 v89, s28, v89
    v_mul_f32 v90, s28, v90
    v_mul_f32 v91, s28, v91
    v_cvt_pk_bf16_f32 v142, v88, v89
    v_cvt_pk_bf16_f32 v143, v90, v91
    buffer_store_dwordx2 v[142:143], v25, s[12:15], 0 offen sc1
    v_mfma_f32_32x32x16_bf16 v[100:115], v[172:175], v[168:171], v[100:115]
    v_mul_f32 v92, s28, v92
    v_mul_f32 v93, s28, v93
    v_mul_f32 v94, s28, v94
    v_mul_f32 v95, s28, v95
    v_cvt_pk_bf16_f32 v144, v92, v93
    v_cvt_pk_bf16_f32 v145, v94, v95
    buffer_store_dwordx2 v[144:145], v26, s[12:15], 0 offen sc1
    s_waitcnt lgkmcnt(0)
    v_mfma_f32_32x32x16_bf16 v[100:115], v[188:191], v[184:187], v[100:115]
    v_mul_f32 v96, s28, v96
    v_mul_f32 v97, s28, v97
    v_mul_f32 v98, s28, v98
    v_mul_f32 v99, s28, v99
    v_cvt_pk_bf16_f32 v146, v96, v97
    v_cvt_pk_bf16_f32 v147, v98, v99
    buffer_store_dwordx2 v[146:147], v27, s[12:15], 0 offen sc1
    v_mfma_f32_32x32x16_bf16 v[100:115], v[204:207], v[200:203], v[100:115]
    v_mfma_f32_32x32x16_bf16 v[100:115], v[224:227], v[220:223], v[100:115]
    v_mfma_f32_32x32x16_bf16 v[100:115], v[240:243], v[236:239], v[100:115]
    v_mfma_f32_32x32x16_bf16 v[116:131], v[48:51], v[40:43], v[116:131]
    s_nop 7
    v_mfma_f32_32x32x16_bf16 v[116:131], v[64:67], v[56:59], v[116:131]
    s_nop 1
    v_mul_f32 v100, s28, v100
    v_mul_f32 v101, s28, v101
    v_mul_f32 v102, s28, v102
    v_mul_f32 v103, s28, v103
    v_cvt_pk_bf16_f32 v132, v100, v101
    v_cvt_pk_bf16_f32 v133, v102, v103
    buffer_store_dwordx2 v[132:133], v28, s[12:15], 0 offen sc1
    v_mfma_f32_32x32x16_bf16 v[116:131], v[160:163], v[152:155], v[116:131]
    v_mul_f32 v104, s28, v104
    v_mul_f32 v105, s28, v105
    v_mul_f32 v106, s28, v106
    v_mul_f32 v107, s28, v107
    v_cvt_pk_bf16_f32 v134, v104, v105
    v_cvt_pk_bf16_f32 v135, v106, v107
    buffer_store_dwordx2 v[134:135], v29, s[12:15], 0 offen sc1
    v_mfma_f32_32x32x16_bf16 v[116:131], v[176:179], v[168:171], v[116:131]
    v_mul_f32 v108, s28, v108
    v_mul_f32 v109, s28, v109
    v_mul_f32 v110, s28, v110
    v_mul_f32 v111, s28, v111
    v_cvt_pk_bf16_f32 v136, v108, v109
    v_cvt_pk_bf16_f32 v137, v110, v111
    buffer_store_dwordx2 v[136:137], v30, s[12:15], 0 offen sc1
    v_mfma_f32_32x32x16_bf16 v[116:131], v[192:195], v[184:187], v[116:131]
    v_mul_f32 v112, s28, v112
    v_mul_f32 v113, s28, v113
    v_mul_f32 v114, s28, v114
    v_mul_f32 v115, s28, v115
    v_cvt_pk_bf16_f32 v138, v112, v113
    v_cvt_pk_bf16_f32 v139, v114, v115
    buffer_store_dwordx2 v[138:139], v31, s[12:15], 0 offen sc1
    v_mfma_f32_32x32x16_bf16 v[116:131], v[208:211], v[200:203], v[116:131]
    v_mfma_f32_32x32x16_bf16 v[116:131], v[228:231], v[220:223], v[116:131]
    v_mfma_f32_32x32x16_bf16 v[116:131], v[244:247], v[236:239], v[116:131]
    s_nop 11
    v_mul_f32 v116, s28, v116
    v_mul_f32 v117, s28, v117
    v_mul_f32 v118, s28, v118
    v_mul_f32 v119, s28, v119
    v_cvt_pk_bf16_f32 v140, v116, v117
    v_cvt_pk_bf16_f32 v141, v118, v119
    buffer_store_dwordx2 v[140:141], v32, s[12:15], 0 offen sc1
    v_mul_f32 v120, s28, v120
    v_mul_f32 v121, s28, v121
    v_mul_f32 v122, s28, v122
    v_mul_f32 v123, s28, v123
    v_cvt_pk_bf16_f32 v142, v120, v121
    v_cvt_pk_bf16_f32 v143, v122, v123
    buffer_store_dwordx2 v[142:143], v33, s[12:15], 0 offen sc1
    v_mul_f32 v124, s28, v124
    v_mul_f32 v125, s28, v125
    v_mul_f32 v126, s28, v126
    v_mul_f32 v127, s28, v127
    v_cvt_pk_bf16_f32 v144, v124, v125
    v_cvt_pk_bf16_f32 v145, v126, v127
    buffer_store_dwordx2 v[144:145], v34, s[12:15], 0 offen sc1
    v_mul_f32 v128, s28, v128
    v_mul_f32 v129, s28, v129
    v_mul_f32 v130, s28, v130
    v_mul_f32 v131, s28, v131
    v_cvt_pk_bf16_f32 v146, v128, v129
    v_cvt_pk_bf16_f32 v147, v130, v131
    buffer_store_dwordx2 v[146:147], v35, s[12:15], 0 offen sc1
    s_branch Lg_done
Lg_vtype:
    s_sub_u32 s27, s21, 9
    s_lshl_b32 s27, s27, 7
    s_lshl_b32 s28, s24, 6
    s_add_u32 s27, s27, s28
    s_mul_i32 s28, s26, 36864
    s_add_u32 s28, s28, 17571840
    v_mul_u32_u24 v4, 9216, v6
    v_add_u32 v1, s27, v5
    v_lshl_add_u32 v20, v1, 4, v4
    s_cmp_ge_u32 s27, 576
    s_cselect_b32 s29, 0x7f000000, 0
    v_add_u32 v20, s29, v20
    s_mov_b32 s31, 7
    s_barrier
    ds_read_b128 v[36:39], v14
    ds_read_b64_tr_b16 v[44:45], v18 offset:16384
    ds_read_b64_tr_b16 v[46:47], v18 offset:17408
    ds_read_b64_tr_b16 v[48:49], v19 offset:16384
    ds_read_b64_tr_b16 v[50:51], v19 offset:17408
    ds_read_b128 v[40:43], v14 offset:4096
.p2align 6
Lg_v:
    s_waitcnt lgkmcnt(3)
    v_mfma_f32_32x32x16_bf16 v[68:83], v[36:39], v[44:47], v[68:83]
    ds_read_b128 v[52:55], v15
    ds_read_b64_tr_b16 v[60:61], v18 offset:20480
    ds_read_b64_tr_b16 v[62:63], v18 offset:21504
    s_waitcnt lgkmcnt(4)
    v_mfma_f32_32x32x16_bf16 v[84:99], v[36:39], v[48:51], v[84:99]
    ds_read_b64_tr_b16 v[64:65], v19 offset:20480
    ds_read_b64_tr_b16 v[66:67], v19 offset:21504
    ds_read_b128 v[56:59], v15 offset:4096
    s_waitcnt lgkmcnt(6)
    v_mfma_f32_32x32x16_bf16 v[100:115], v[40:43], v[44:47], v[100:115]
    v_mfma_f32_32x32x16_bf16 v[116:131], v[40:43], v[48:51], v[116:131]
    s_waitcnt lgkmcnt(3)
    v_mfma_f32_32x32x16_bf16 v[68:83], v[52:55], v[60:63], v[68:83]
    ds_read_b128 v[36:39], v16
    ds_read_b64_tr_b16 v[44:45], v18 offset:24576
    ds_read_b64_tr_b16 v[46:47], v18 offset:25600
    s_waitcnt lgkmcnt(4)
    v_mfma_f32_32x32x16_bf16 v[84:99], v[52:55], v[64:67], v[84:99]
    ds_read_b64_tr_b16 v[48:49], v19 offset:24576
    ds_read_b64_tr_b16 v[50:51], v19 offset:25600
    ds_read_b128 v[40:43], v16 offset:4096
    s_waitcnt lgkmcnt(6)
    v_mfma_f32_32x32x16_bf16 v[100:115], v[56:59], v[60:63], v[100:115]
    v_mfma_f32_32x32x16_bf16 v[116:131], v[56:59], v[64:67], v[116:131]
    s_waitcnt lgkmcnt(3)
    v_mfma_f32_32x32x16_bf16 v[68:83], v[36:39], v[44:47], v[68:83]
    ds_read_b128 v[52:55], v17
    ds_read_b64_tr_b16 v[60:61], v18 offset:28672
    ds_read_b64_tr_b16 v[62:63], v18 offset:29696
    s_waitcnt lgkmcnt(4)
    v_mfma_f32_32x32x16_bf16 v[84:99], v[36:39], v[48:51], v[84:99]
    ds_read_b64_tr_b16 v[64:65], v19 offset:28672
    ds_read_b64_tr_b16 v[66:67], v19 offset:29696
    ds_read_b128 v[56:59], v17 offset:4096
    s_waitcnt lgkmcnt(6)
    v_mfma_f32_32x32x16_bf16 v[100:115], v[40:43], v[44:47], v[100:115]
    s_add_u32 s30, s30, 32768
    s_and_b32 s30, s30, 131071
    s_sub_u32 s31, s31, 1
    s_cmp_eq_u32 s31, 0
    v_mfma_f32_32x32x16_bf16 v[116:131], v[40:43], v[48:51], v[116:131]
    s_barrier
    v_add_u32 v14, s30, v8
    v_add_u32 v15, s30, v9
    v_add_u32 v16, s30, v10
    v_add_u32 v17, s30, v11
    v_add_u32 v18, s30, v12
    v_add_u32 v19, s30, v13
    s_waitcnt lgkmcnt(3)
    v_mfma_f32_32x32x16_bf16 v[68:83], v[52:55], v[60:63], v[68:83]
    ds_read_b128 v[36:39], v14
    ds_read_b64_tr_b16 v[44:45], v18 offset:16384
    ds_read_b64_tr_b16 v[46:47], v18 offset:17408
    s_waitcnt lgkmcnt(4)
    v_mfma_f32_32x32x16_bf16 v[84:99], v[52:55], v[64:67], v[84:99]
    ds_read_b64_tr_b16 v[48:49], v19 offset:16384
    ds_read_b64_tr_b16 v[50:51], v19 offset:17408
    ds_read_b128 v[40:43], v14 offset:4096
    s_waitcnt lgkmcnt(6)
    v_mfma_f32_32x32x16_bf16 v[100:115], v[56:59], v[60:63], v[100:115]
    v_mfma_f32_32x32x16_bf16 v[116:131], v[56:59], v[64:67], v[116:131]
    s_cbranch_scc0 Lg_v
    ds_read_b128 v[52:55], v15
    ds_read_b64_tr_b16 v[60:61], v18 offset:20480
    ds_read_b64_tr_b16 v[62:63], v18 offset:21504
    ds_read_b128 v[148:151], v16
    ds_read_b64_tr_b16 v[156:157], v18 offset:24576
    ds_read_b64_tr_b16 v[158:159], v18 offset:25600
    ds_read_b128 v[164:167], v17
    ds_read_b64_tr_b16 v[172:173], v18 offset:28672
    ds_read_b64_tr_b16 v[174:175], v18 offset:29696
    s_waitcnt lgkmcnt(9)
    v_mfma_f32_32x32x16_bf16 v[68:83], v[36:39], v[44:47], v[68:83]
    ds_read_b64_tr_b16 v[64:65], v19 offset:20480
    ds_read_b64_tr_b16 v[66:67], v19 offset:21504
    s_waitcnt lgkmcnt(8)
    v_mfma_f32_32x32x16_bf16 v[68:83], v[52:55], v[60:63], v[68:83]
    ds_read_b64_tr_b16 v[160:161], v19 offset:24576
    ds_read_b64_tr_b16 v[162:163], v19 offset:25600
    s_waitcnt lgkmcnt(7)
    v_mfma_f32_32x32x16_bf16 v[68:83], v[148:151], v[156:159], v[68:83]
    ds_read_b64_tr_b16 v[176:177], v19 offset:28672
    ds_read_b64_tr_b16 v[178:179], v19 offset:29696
    s_waitcnt lgkmcnt(6)
    v_mfma_f32_32x32x16_bf16 v[68:83], v[164:167], v[172:175], v[68:83]
    ds_read_b128 v[56:59], v15 offset:4096
    ds_read_b128 v[152:155], v16 offset:4096
    ds_read_b128 v[168:171], v17 offset:4096
    s_add_u32 s30, s30, 32768
    s_and_b32 s30, s30, 131071
    s_barrier
    v_add_u32 v14, s30, v8
    v_add_u32 v15, s30, v9
    v_add_u32 v16, s30, v10
    v_add_u32 v17, s30, v11
    v_add_u32 v18, s30, v12
    v_add_u32 v19, s30, v13
    s_waitcnt lgkmcnt(3)
    v_mfma_f32_32x32x16_bf16 v[84:99], v[36:39], v[48:51], v[84:99]
    ds_read_b128 v[180:183], v14
    ds_read_b64_tr_b16 v[188:189], v18 offset:16384
    ds_read_b64_tr_b16 v[190:191], v18 offset:17408
    v_mfma_f32_32x32x16_bf16 v[84:99], v[52:55], v[64:67], v[84:99]
    ds_read_b128 v[196:199], v15
    ds_read_b64_tr_b16 v[204:205], v18 offset:20480
    ds_read_b64_tr_b16 v[206:207], v18 offset:21504
    v_mfma_f32_32x32x16_bf16 v[84:99], v[148:151], v[160:163], v[84:99]
    ds_read_b128 v[216:219], v16
    ds_read_b64_tr_b16 v[224:225], v18 offset:24576
    ds_read_b64_tr_b16 v[226:227], v18 offset:25600
    v_mfma_f32_32x32x16_bf16 v[84:99], v[164:167], v[176:179], v[84:99]
    ds_read_b128 v[232:235], v17
    ds_read_b64_tr_b16 v[240:241], v18 offset:28672
    ds_read_b64_tr_b16 v[242:243], v18 offset:29696
    s_waitcnt lgkmcnt(9)
    v_mfma_f32_32x32x16_bf16 v[68:83], v[180:183], v[188:191], v[68:83]
    ds_read_b64_tr_b16 v[192:193], v19 offset:16384
    ds_read_b64_tr_b16 v[194:195], v19 offset:17408
    s_waitcnt lgkmcnt(8)
    v_mfma_f32_32x32x16_bf16 v[68:83], v[196:199], v[204:207], v[68:83]
    ds_read_b64_tr_b16 v[208:209], v19 offset:20480
    ds_read_b64_tr_b16 v[210:211], v19 offset:21504
    s_waitcnt lgkmcnt(7)
    v_mfma_f32_32x32x16_bf16 v[68:83], v[216:219], v[224:227], v[68:83]
    ds_read_b64_tr_b16 v[228:229], v19 offset:24576
    ds_read_b64_tr_b16 v[230:231], v19 offset:25600
    s_waitcnt lgkmcnt(6)
    v_mfma_f32_32x32x16_bf16 v[68:83], v[232:235], v[240:243], v[68:83]
    ds_read_b64_tr_b16 v[244:245], v19 offset:28672
    ds_read_b64_tr_b16 v[246:247], v19 offset:29696
    s_waitcnt lgkmcnt(0)
    v_mfma_f32_32x32x16_bf16 v[84:99], v[180:183], v[192:195], v[84:99]
    ds_read_b128 v[184:187], v14 offset:4096
    ds_read_b128 v[200:203], v15 offset:4096
    ds_read_b128 v[220:223], v16 offset:4096
    ds_read_b128 v[236:239], v17 offset:4096
    s_nop 3
    v_mfma_f32_32x32x16_bf16 v[84:99], v[196:199], v[208:211], v[84:99]
    v_cvt_pk_bf16_f32 v132, v68, v69
    v_cvt_pk_bf16_f32 v133, v70, v71
    v_cvt_pk_bf16_f32 v134, v72, v73
    v_mfma_f32_32x32x16_bf16 v[84:99], v[216:219], v[228:231], v[84:99]
    v_cvt_pk_bf16_f32 v135, v74, v75
    s_add_u32 s29, s28, 0
    buffer_store_dwordx4 v[132:135], v20, s[12:15], s29 offen offset:0 sc1
    v_mfma_f32_32x32x16_bf16 v[84:99], v[232:235], v[244:247], v[84:99]
    v_cvt_pk_bf16_f32 v136, v76, v77
    v_cvt_pk_bf16_f32 v137, v78, v79
    v_cvt_pk_bf16_f32 v138, v80, v81
    v_mfma_f32_32x32x16_bf16 v[100:115], v[40:43], v[44:47], v[100:115]
    s_nop 7
    v_cvt_pk_bf16_f32 v139, v82, v83
    s_add_u32 s29, s28, 18432
    buffer_store_dwordx4 v[136:139], v20, s[12:15], s29 offen offset:0 sc1
    v_mfma_f32_32x32x16_bf16 v[100:115], v[56:59], v[60:63], v[100:115]
    s_nop 1
    v_cvt_pk_bf16_f32 v140, v84, v85
    v_cvt_pk_bf16_f32 v141, v86, v87
    v_cvt_pk_bf16_f32 v142, v88, v89
    v_mfma_f32_32x32x16_bf16 v[100:115], v[152:155], v[156:159], v[100:115]
    v_cvt_pk_bf16_f32 v143, v90, v91
    s_add_u32 s29, s28, 0
    buffer_store_dwordx4 v[140:143], v20, s[12:15], s29 offen offset:512 sc1
    v_mfma_f32_32x32x16_bf16 v[100:115], v[168:171], v[172:175], v[100:115]
    v_cvt_pk_bf16_f32 v144, v92, v93
    v_cvt_pk_bf16_f32 v145, v94, v95
    v_cvt_pk_bf16_f32 v146, v96, v97
    s_waitcnt lgkmcnt(0)
    v_mfma_f32_32x32x16_bf16 v[100:115], v[184:187], v[188:191], v[100:115]
    v_cvt_pk_bf16_f32 v147, v98, v99
    s_add_u32 s29, s28, 18432
    buffer_store_dwordx4 v[144:147], v20, s[12:15], s29 offen offset:512 sc1
    v_mfma_f32_32x32x16_bf16 v[100:115], v[200:203], v[204:207], v[100:115]
    v_mfma_f32_32x32x16_bf16 v[100:115], v[220:223], v[224:227], v[100:115]
    v_mfma_f32_32x32x16_bf16 v[100:115], v[236:239], v[240:243], v[100:115]
    v_mfma_f32_32x32x16_bf16 v[116:131], v[40:43], v[48:51], v[116:131]
    s_nop 7
    v_mfma_f32_32x32x16_bf16 v[116:131], v[56:59], v[64:67], v[116:131]
    s_nop 1
    v_cvt_pk_bf16_f32 v132, v100, v101
    v_cvt_pk_bf16_f32 v133, v102, v103
    v_cvt_pk_bf16_f32 v134, v104, v105
    v_mfma_f32_32x32x16_bf16 v[116:131], v[152:155], v[160:163], v[116:131]
    v_cvt_pk_bf16_f32 v135, v106, v107
    s_add_u32 s29, s28, 36864
    buffer_store_dwordx4 v[132:135], v20, s[12:15], s29 offen offset:0 sc1
    v_mfma_f32_32x32x16_bf16 v[116:131], v[168:171], v[176:179], v[116:131]
    v_cvt_pk_bf16_f32 v136, v108, v109
    v_cvt_pk_bf16_f32 v137, v110, v111
    v_cvt_pk_bf16_f32 v138, v112, v113
    v_mfma_f32_32x32x16_bf16 v[116:131], v[184:187], v[192:195], v[116:131]
    v_cvt_pk_bf16_f32 v139, v114, v115
    s_add_u32 s29, s28, 55296
    buffer_store_dwordx4 v[136:139], v20, s[12:15], s29 offen offset:0 sc1
    v_mfma_f32_32x32x16_bf16 v[116:131], v[200:203], v[208:211], v[116:131]
    v_mfma_f32_32x32x16_bf16 v[116:131], v[220:223], v[228:231], v[116:131]
    v_mfma_f32_32x32x16_bf16 v[116:131], v[236:239], v[244:247], v[116:131]
    s_nop 11
    v_cvt_pk_bf16_f32 v140, v116, v117
    v_cvt_pk_bf16_f32 v141, v118, v119
    v_cvt_pk_bf16_f32 v142, v120, v121
    v_cvt_pk_bf16_f32 v143, v122, v123
    s_add_u32 s29, s28, 36864
    buffer_store_dwordx4 v[140:143], v20, s[12:15], s29 offen offset:512 sc1
    v_cvt_pk_bf16_f32 v144, v124, v125
    v_cvt_pk_bf16_f32 v145, v126, v127
    v_cvt_pk_bf16_f32 v146, v128, v129
    v_cvt_pk_bf16_f32 v147, v130, v131
    s_add_u32 s29, s28, 55296
    buffer_store_dwordx4 v[144:147], v20, s[12:15], s29 offen offset:512 sc1
Lg_done:
    s_setprio 2
    s_cmp_lg_u32 s16, 0
    s_cbranch_scc1 Lg_d2
    v_and_b32 v9, 7, v0
    v_lshlrev_b32 v9, 2, v9
    s_mov_b32 s93, 200000
Lr2:
    global_load_dword v8, v9, s[84:85] sc1
    s_waitcnt vmcnt(0)
    v_cmp_eq_u32 vcc, 0, v8
    s_nop 3
    s_cmp_eq_u64 vcc, 0
    s_cbranch_scc1 Ld3
    s_sleep 2
    s_sub_u32 s93, s93, 1
    s_cmp_lg_u32 s93, 0
    s_cbranch_scc1 Lr2
Ld3:
Lg_d2:
    s_waitcnt vmcnt(0) lgkmcnt(0)
    v_mov_b32 v8, s3
    v_mov_b32 v9, 5
    ds_write_b32 v8, v9
    v_mov_b32 v12, s94
    s_mov_b32 s93, 200000
Lw4:
    ds_read_b128 v[8:11], v12
    s_waitcnt lgkmcnt(0)
    v_min_u32 v8, v8, v9
    v_min3_u32 v8, v8, v10, v11
    s_nop 0
    v_readfirstlane_b32 s92, v8
    s_cmp_ge_u32 s92, 5
    s_cbranch_scc1 Ld5
    s_sleep 1
    s_sub_u32 s93, s93, 1
    s_cmp_lg_u32 s93, 0
    s_cbranch_scc1 Lw4
Ld5:
    s_cmp_lg_u32 s16, 0
    s_cbranch_scc1 Lattn
    s_lshl_b32 s92, s21, 8
    s_add_u32 s92, s92, 16523264
    v_lshlrev_b32 v8, 15, v0
    v_mov_b32 v9, 1
    s_mov_b64 exec, s[36:37]
    buffer_atomic_add v9, v8, s[12:15], s92 offen sc1
    s_mov_b64 exec, -1
    s_waitcnt vmcnt(0)
    s_branch Lattn
Ls1:
    s_waitcnt lgkmcnt(0)
    s_mov_b32 s12, s86
    s_mov_b32 s13, s87
    s_mov_b32 s14, 22028288
    s_mov_b32 s15, 0x20000
    s_sub_u32 s17, s2, 224
    s_cmp_lt_u32 s16, 4
    s_cbranch_scc1 Lx_a
    s_mov_b32 s95, 1
    s_mov_b32 s18, 8
    s_lshl_b32 s19, s17, 1
    s_add_u32 s19, s19, 512
    s_bfe_u32 s25, s2, 0x10003
    s_lshl_b32 s25, s25, 14
    s_add_u32 s96, s25, 40960
    s_add_u32 s97, s25, 111616
    s_add_u32 s99, s97, 9344
    s_add_u32 s3, s3, 32
    s_add_u32 s94, s94, 32
    s_branch Lb_setup
Lx_a:
    s_cmp_ge_u32 s17, 8
    s_cbranch_scc1 Lx_1
    s_cmp_lg_u32 s16, 0
    s_cbranch_scc1 Lx_1
    v_lshlrev_b32 v11, 8, v0
    v_mov_b32 v12, 0
    s_lshl_b32 s25, s17, 15
    s_add_u32 s25, s25, 16523264
    buffer_store_dword v12, v11, s[12:15], s25 offen sc1
    s_add_u32 s25, s25, 16384
    s_mov_b64 exec, 0xfffff
    buffer_store_dword v12, v11, s[12:15], s25 offen sc1
    s_mov_b64 exec, -1
    v_lshlrev_b32 v11, 2, v0
    s_add_u32 s25, s25, 14336
    buffer_store_dword v12, v11, s[12:15], s25 offen sc1
Lx_1:
    s_getpc_b64 s[26:27]
Lpc0:
    s_add_u32 s26, s26, Lcode_begin-Lpc0
    s_addc_u32 s27, s27, -1
    s_lshl_b32 s25, s16, 13
    v_lshlrev_b32 v13, 7, v0
    v_add_u32 v13, s25, v13
    v_min_u32 v13, Lcode_end-Lcode_begin-4, v13
    v_mov_b32 v15, s27
    v_add_co_u32 v14, vcc, s26, v13
    s_nop 1
    v_addc_co_u32 v15, vcc, 0, v15, vcc
    global_load_dword v210, v[14:15], off
    s_and_b32 s25, s16, 3
    s_lshl_b32 s25, s25, 7
    s_add_u32 s25, s25, 4294967282
    v_add_u32 v148, s25, v0
    v_mul_u32_u24 v149, 1821, v148
    v_lshrrev_b32 v149, 16, v149
    v_mul_u32_u24 v149, 36, v149
    v_cmp_eq_u32 s[34:35], v149, v148
    v_cmp_gt_u32 vcc, 288, v148
    v_mov_b32 v149, 0x3f803f80
    v_lshlrev_b32 v148, 4, v148
    s_and_b64 vcc, vcc, s[34:35]
    v_add_u32 v148, 155872, v148
    v_cndmask_b32 v144, 0, v149, vcc
    v_cndmask_b32 v145, 0, v149, vcc
    v_cndmask_b32 v146, 0, v149, vcc
    v_cndmask_b32 v147, 0, v149, vcc
    ds_write_b128 v148, v[144:147]
    s_and_b32 s25, s16, 3
    s_lshl_b32 s25, s25, 7
    s_add_u32 s25, s25, 50
    v_add_u32 v148, s25, v0
    v_mul_u32_u24 v149, 1821, v148
    v_lshrrev_b32 v149, 16, v149
    v_mul_u32_u24 v149, 36, v149
    v_cmp_eq_u32 s[34:35], v149, v148
    v_cmp_gt_u32 vcc, 288, v148
    v_mov_b32 v149, 0x3f803f80
    v_lshlrev_b32 v148, 4, v148
    s_and_b64 vcc, vcc, s[34:35]
    v_add_u32 v148, 155872, v148
    v_cndmask_b32 v144, 0, v149, vcc
    v_cndmask_b32 v145, 0, v149, vcc
    v_cndmask_b32 v146, 0, v149, vcc
    v_cndmask_b32 v147, 0, v149, vcc
    ds_write_b128 v148, v[144:147]
    s_cmp_ge_u32 s17, 8
    s_cbranch_scc1 Lx_2
    s_cmp_lg_u32 s16, 0
    s_cbranch_scc1 Lx_2
    s_lshl_b32 s27, s17, 2
    v_mov_b32 v11, s27
    v_mov_b32 v12, 1
    s_mov_b64 exec, 1
    s_waitcnt vmcnt(1)
    global_store_dword v11, v12, s[84:85] sc1
    s_mov_b64 exec, -1
Lx_2:
    s_mov_b32 s95, 1
    s_lshr_b32 s17, s2, 3
    s_and_b32 s18, s2, 7
    s_lshl_b32 s19, s2, 1
    s_mov_b32 s96, 0
    s_mov_b32 s97, 0
    s_mov_b32 s99, 0
    s_branch Lb_setup
Lh_restart:
    s_sub_u32 s3, s3, 32
    s_sub_u32 s94, s94, 32
Lh_start:
    s_mov_b32 s95, 0
    s_lshr_b32 s17, s2, 3
    s_and_b32 s18, s2, 7
    s_lshl_b32 s19, s2, 1
    s_bfe_u32 s25, s2, 0x10003
    s_lshl_b32 s96, s25, 14
    s_add_u32 s97, s96, 65536
    s_add_u32 s99, s96, 120832
Lb_setup:
    s_and_b32 s23, s16, 3
    v_and_b32 v1, 7, v0
    v_lshrrev_b32 v2, 3, v0
    s_lshl_b32 s21, s18, 9
    v_lshlrev_b32 v4, 6, v1
    s_mov_b32 s4, s76
    s_mov_b32 s5, s77
    s_mov_b32 s6, 4608
    s_mov_b32 s7, 0x20000
    buffer_load_dwordx4 v[68:71], v4, s[4:7], s21 offen offset:0
    buffer_load_dwordx4 v[72:75], v4, s[4:7], s21 offen offset:16
    buffer_load_dwordx4 v[76:79], v4, s[4:7], s21 offen offset:32
    buffer_load_dwordx4 v[80:83], v4, s[4:7], s21 offen offset:48
    s_mul_i32 s20, s17, 73728
    s_lshl_b32 s21, s18, 7
    s_add_u32 s20, s20, s21
    v_mul_u32_u24 v3, 1152, v2
    v_lshl_add_u32 v3, v1, 4, v3
    v_add_u32 v3, s20, v3
    v_add_u32 v186, 70272, v3
    s_mul_i32 s20, s23, 9216
    v_add_u32 v185, s20, v3
    v_subrev_u32 v184, 3456, v185
    v_lshlrev_b32 v9, 4, v0
    s_add_u32 s28, s97, 9344
    s_lshr_b32 s25, s23, 1
    s_add_u32 s98, s19, s25
    s_cmp_eq_u32 s25, 0
    s_cselect_b32 s96, s96, s28
    s_mul_i32 s25, s25, 4672
    s_add_u32 s97, s97, s25
    s_add_u32 s97, s97, 576
    s_lshl_b32 s25, s19, 1
    s_load_dword s100, s[80:81], s25
    s_cmp_eq_u32 s95, 1
    s_cbranch_scc1 Lb_load
Lb_setup2:
    v_lshlrev_b32 v187, 8, v2
    v_lshl_add_u32 v187, v1, 4, v187
    s_lshl_b32 s25, s23, 11
    s_add_u32 s25, s25, s99
    v_add_u32 v187, s25, v187
    v_lshrrev_b32 v3, 4, v0
    v_and_b32 v4, 15, v0
    v_lshlrev_b32 v4, 7, v4
    v_lshl_add_u32 v189, v3, 4, v4
    v_add_u32 v189, s25, v189
    v_add_u32 v190, s25, v9
    v_bfe_u32 v4, v0, 2, 2
    v_lshl_add_u32 v188, v3, 3, v4
    v_lshlrev_b32 v188, 7, v188
    v_and_b32 v4, 3, v0
    v_lshl_add_u32 v188, v4, 3, v188
    v_lshlrev_b32 v193, 8, v4
    v_add_u32 v193, 160000, v193
    s_lshl_b32 s25, s23, 5
    s_add_u32 s25, s25, s99
    v_add_u32 v188, s25, v188
    v_lshlrev_b32 v191, 12, v2
    v_lshl_add_u32 v191, v1, 4, v191
    s_lshl_b32 s22, s18, 2
    s_add_u32 s22, s22, s23
    s_lshl_b32 s22, s22, 16
    s_lshl_b32 s25, s17, 7
    s_add_u32 s22, s22, s25
    s_add_u32 s22, s22, 11800576
    s_lshr_b32 s25, s18, 3
    s_lshl_b32 s25, s25, 12
    s_add_u32 s22, s22, s25
    v_add_u32 v191, s22, v191
    v_min_u32 v192, 35, v0
    v_lshlrev_b32 v192, 4, v192
    s_sub_u32 s25, s97, 576
    v_add_u32 v192, s25, v192
    s_waitcnt lgkmcnt(0)
    v_bfe_u32 v19, v0, 2, 2
    v_mul_u32_u24 v16, 4160, v19
    v_and_b32 v19, 3, v0
    v_lshl_add_u32 v16, v19, 3, v16
    v_lshrrev_b32 v19, 4, v0
    v_lshlrev_b32 v17, 4, v19
    v_sub_u32 v16, v16, v17
    s_add_u32 s25, s96, 88
    v_add_u32 v16, s25, v16
    v_and_b32 v18, 15, v0
    v_lshlrev_b32 v18, 5, v18
    v_add_u32 v17, v17, v18
    s_sub_u32 s25, s97, 96
    v_add_u32 v17, s25, v17
    v_lshl_add_u32 v18, v19, 3, v18
    v_and_b32 v20, 15, v0
    v_lshlrev_b32 v19, 3, v19
    v_sub_u32 v19, v20, v19
    v_add_u32 v19, 17, v19
    v_mov_b32 v24, 0xffff
    v_mov_b32 v25, 0xffff0000
    v_cmp_lt_i32 vcc, 0, v19
    v_cmp_lt_i32 s[26:27], 1, v19
    s_nop 0
    v_cndmask_b32 v20, 0, v24, vcc
    v_cndmask_b32 v26, 0, v25, s[26:27]
    v_or_b32 v20, v20, v26
    v_cmp_lt_i32 vcc, 2, v19
    v_cmp_lt_i32 s[26:27], 3, v19
    s_nop 0
    v_cndmask_b32 v21, 0, v24, vcc
    v_cndmask_b32 v26, 0, v25, s[26:27]
    v_or_b32 v21, v21, v26
    v_cmp_lt_i32 vcc, 4, v19
    v_cmp_lt_i32 s[26:27], 5, v19
    s_nop 0
    v_cndmask_b32 v22, 0, v24, vcc
    v_cndmask_b32 v26, 0, v25, s[26:27]
    v_or_b32 v22, v22, v26
    v_cmp_lt_i32 vcc, 6, v19
    v_cmp_lt_i32 s[26:27], 7, v19
    s_nop 0
    v_cndmask_b32 v23, 0, v24, vcc
    v_cndmask_b32 v26, 0, v25, s[26:27]
    v_or_b32 v23, v23, v26
    v_mov_b32 v24, 0
    v_mov_b32 v25, 0
    v_mov_b32 v26, 0
    v_mov_b32 v27, 0
    v_mov_b32 v28, 0
    v_mov_b32 v29, 0
    v_mov_b32 v30, 0
    v_mov_b32 v31, 0
    v_mov_b32 v32, 0
    v_mov_b32 v33, 0
    v_mov_b32 v34, 0
    v_mov_b32 v35, 0
    v_mov_b32 v36, 0
    v_mov_b32 v37, 0
    v_mov_b32 v38, 0
    v_mov_b32 v39, 0
    s_lshl_b32 s101, s98, 12
    s_add_u32 s101, s101, 14163968
    s_lshl_b32 s25, s100, 16
    s_and_b32 s27, s100, 0xffff0000
    s_bitcmp0_b32 s98, 0
    s_cselect_b32 s100, s25, s27
    s_lshr_b32 s25, s100, 16
    v_mov_b32 v194, s25
    v_mov_b32 v195, s100
    s_mov_b32 s29, 0xffff0000
    s_mov_b32 s28, 0xffff
    s_waitcnt vmcnt(0)
    v_and_b32 v216, s28, v68
    v_lshrrev_b32 v218, 16, v68
    v_and_b32 v220, s28, v69
    v_lshrrev_b32 v222, 16, v69
    v_lshlrev_b32 v217, 16, v70
    v_and_b32 v219, s29, v70
    v_lshlrev_b32 v221, 16, v71
    v_and_b32 v223, s29, v71
    v_and_b32 v224, s28, v72
    v_lshrrev_b32 v226, 16, v72
    v_and_b32 v228, s28, v73
    v_lshrrev_b32 v230, 16, v73
    v_lshlrev_b32 v225, 16, v74
    v_and_b32 v227, s29, v74
    v_lshlrev_b32 v229, 16, v75
    v_and_b32 v231, s29, v75
    v_and_b32 v232, s28, v76
    v_lshrrev_b32 v234, 16, v76
    v_and_b32 v236, s28, v77
    v_lshrrev_b32 v238, 16, v77
    v_lshlrev_b32 v233, 16, v78
    v_and_b32 v235, s29, v78
    v_lshlrev_b32 v237, 16, v79
    v_and_b32 v239, s29, v79
    v_and_b32 v240, s28, v80
    v_lshrrev_b32 v242, 16, v80
    v_and_b32 v244, s28, v81
    v_lshrrev_b32 v246, 16, v81
    v_lshlrev_b32 v241, 16, v82
    v_and_b32 v243, s29, v82
    v_lshlrev_b32 v245, 16, v83
    v_and_b32 v247, s29, v83
    s_cmp_eq_u32 s95, 0
    s_cbranch_scc1 Lh_kv
    s_barrier
    s_branch Lb_s0
Lh_kv:
    s_and_b32 s17, s2, 7
    s_lshl_b32 s17, s17, 2
    s_bfe_u32 s25, s2, 0x20003
    s_add_u32 s17, s17, s25
    s_lshr_b32 s18, s2, 5
    s_and_b32 s20, s16, 3
    s_and_b32 s21, s17, 1
    s_lshr_b32 s26, s17, 1
    v_lshlrev_b32 v9, 4, v0
    s_mul_i32 s39, s26, 294912
    s_mul_i32 s28, s21, 139264
    s_add_u32 s27, s39, s28
    s_add_u32 s27, s27, 4718592
    s_add_u32 s8, s86, s27
    s_addc_u32 s9, s87, 0
    s_mov_b32 s10, 155648
    s_mov_b32 s11, 0x20000
    s_lshl_b32 s22, s21, 14
    s_add_u32 s23, s22, 65536
    s_cmp_eq_u32 s21, 0
    s_cselect_b32 s24, 139264, 0
    s_lshl_b32 s25, s20, 10
    s_add_u32 s40, s22, s25
    s_add_u32 s41, s23, s25
    s_add_u32 s42, s23, 8192
    s_and_b32 s44, s20, 1
    s_lshl_b32 s44, s44, 10
    s_add_u32 s44, s44, s24
    s_mul_i32 s43, s17, 288
    s_add_u32 s43, s43, 17571840
    s_add_u32 s46, s44, s27
    s_cmp_eq_u32 s20, 0
    s_cselect_b32 s42, s42, s44
    s_cselect_b32 s44, s43, s46
    s_cselect_b32 s45, 9, 2
    s_cselect_b32 s47, 288, 2
    s_cselect_b64 vcc, -1, 0
    s_lshl_b32 s45, s45, 10
    s_lshl_b32 s47, s47, 10
    s_lshl_b32 s25, s20, 6
    s_add_u32 s46, s25, 256
    v_add_u32 v5, s25, v0
    v_mul_u32_u24 v7, 3641, v5
    v_lshrrev_b32 v7, 16, v7
    v_mul_u32_u24 v8, 8928, v7
    v_lshl_add_u32 v181, v5, 4, v8
    v_add_u32 v5, s46, v0
    v_mul_u32_u24 v7, 3641, v5
    v_lshrrev_b32 v7, 16, v7
    v_mul_u32_u24 v8, 8928, v7
    v_lshl_add_u32 v182, v5, 4, v8
    v_add_u32 v5, 512, v0
    v_mul_u32_u24 v7, 3641, v5
    v_lshrrev_b32 v7, 16, v7
    v_mul_u32_u24 v8, 8928, v7
    v_lshl_add_u32 v183, v5, 4, v8
    v_cndmask_b32 v183, v9, v183, vcc
    s_add_u32 s40, s40, 8192
    s_add_u32 s41, s41, 9216
    s_add_u32 s43, s43, 294912
    s_mul_i32 s25, s45, 1
    s_add_u32 s42, s42, s25
    s_mul_i32 s25, s47, 1
    s_add_u32 s44, s44, s25
    v_mov_b32 v172, 161024
    s_mov_b32 s93, 200000
Lw6:
    ds_read_b128 v[168:171], v172
    s_waitcnt lgkmcnt(0)
    v_min_u32 v168, v168, v169
    v_min3_u32 v168, v168, v170, v171
    s_nop 0
    v_readfirstlane_b32 s92, v168
    s_cmp_ge_u32 s92, 9
    s_cbranch_scc1 Ld7
    s_sleep 2
    s_sub_u32 s93, s93, 1
    s_cmp_lg_u32 s93, 0
    s_cbranch_scc1 Lw6
Ld7:
    s_setprio 1
    s_cmp_ge_u32 s2, 224
    s_cbranch_scc1 Lh_kx
    s_mov_b32 s31, 5
Ldm8:
    s_mov_b32 m0, s40
    s_add_u32 s46, s40, 4096
    buffer_load_dwordx4 v9, s[8:11], s40 offen sc1 lds
    s_mov_b32 m0, s46
    s_add_u32 s40, s40, 8192
    buffer_load_dwordx4 v9, s[8:11], s46 offen sc1 lds
    s_mov_b32 m0, s41
    s_add_u32 s46, s41, 4096
    buffer_load_dwordx4 v181, s[12:15], s43 offen sc1 lds
    s_mov_b32 m0, s46
    s_add_u32 s41, s41, 9216
    buffer_load_dwordx4 v182, s[12:15], s43 offen sc1 lds
    s_mov_b32 m0, s42
    s_add_u32 s43, s43, 294912
    buffer_load_dwordx4 v183, s[12:15], s44 offen sc1 lds
    s_add_u32 s42, s42, s45
    s_add_u32 s44, s44, s47
    s_sub_u32 s31, s31, 1
    s_cmp_lg_u32 s31, 0
    s_cbranch_scc1 Ldm8
    s_waitcnt vmcnt(15)
    v_mov_b32 v168, s3
    v_mov_b32 v169, 1
    ds_write_b32 v168, v169
    v_mov_b32 v172, s94
    s_mov_b32 s93, 200000
Lw9:
    ds_read_b128 v[168:171], v172
    s_waitcnt lgkmcnt(0)
    v_min_u32 v168, v168, v169
    v_min3_u32 v168, v168, v170, v171
    s_nop 0
    v_readfirstlane_b32 s92, v168
    s_cmp_ge_u32 s92, 1
    s_cbranch_scc1 Ld10
    s_sleep 1
    s_sub_u32 s93, s93, 1
    s_cmp_lg_u32 s93, 0
    s_cbranch_scc1 Lw9
Ld10:
    s_cmp_lg_u32 s16, 4
    s_cbranch_scc1 Lav11
    v_mov_b32 v168, 1024
    s_mov_b64 exec, 15
    ds_add_u32 v193, v168
    s_mov_b64 exec, -1
Lav11:
    s_branch Lh_ky
Lh_kx:
    s_add_u32 s40, s40, 16384
    s_add_u32 s41, s41, 18432
    s_add_u32 s43, s43, 589824
    s_mul_i32 s25, s45, 2
    s_add_u32 s42, s42, s25
    s_mul_i32 s25, s47, 2
    s_add_u32 s44, s44, s25
    s_mov_b32 s31, 3
Ldm12:
    s_mov_b32 m0, s40
    s_add_u32 s46, s40, 4096
    buffer_load_dwordx4 v9, s[8:11], s40 offen sc1 lds
    s_mov_b32 m0, s46
    s_add_u32 s40, s40, 8192
    buffer_load_dwordx4 v9, s[8:11], s46 offen sc1 lds
    s_mov_b32 m0, s41
    s_add_u32 s46, s41, 4096
    buffer_load_dwordx4 v181, s[12:15], s43 offen sc1 lds
    s_mov_b32 m0, s46
    s_add_u32 s41, s41, 9216
    buffer_load_dwordx4 v182, s[12:15], s43 offen sc1 lds
    s_mov_b32 m0, s42
    s_add_u32 s43, s43, 294912
    buffer_load_dwordx4 v183, s[12:15], s44 offen sc1 lds
    s_add_u32 s42, s42, s45
    s_add_u32 s44, s44, s47
    s_sub_u32 s31, s31, 1
    s_cmp_lg_u32 s31, 0
    s_cbranch_scc1 Ldm12
    s_mov_b32 s4, s78
    s_mov_b32 s5, s79
    s_mov_b32 s6, 2359296
    s_mov_b32 s7, 0x20000
    s_waitcnt vmcnt(0)
    v_mov_b32 v168, s3
    v_mov_b32 v169, 2
    ds_write_b32 v168, v169
    v_mov_b32 v172, s94
    s_mov_b32 s93, 200000
Lw13:
    ds_read_b128 v[168:171], v172
    s_waitcnt lgkmcnt(0)
    v_min_u32 v168, v168, v169
    v_min3_u32 v168, v168, v170, v171
    s_nop 0
    v_readfirstlane_b32 s92, v168
    s_cmp_ge_u32 s92, 2
    s_cbranch_scc1 Ld14
    s_sleep 1
    s_sub_u32 s93, s93, 1
    s_cmp_lg_u32 s93, 0
    s_cbranch_scc1 Lw13
Ld14:
    s_cmp_lg_u32 s16, 4
    s_cbranch_scc1 Lc_k
    v_mov_b32 v172, 161024
    s_mov_b32 s93, 200000
Lw15:
    ds_read_b128 v[168:171], v172
    s_waitcnt lgkmcnt(0)
    v_min_u32 v168, v168, v169
    v_min3_u32 v168, v168, v170, v171
    s_nop 0
    v_readfirstlane_b32 s92, v168
    s_cmp_ge_u32 s92, 10
    s_cbranch_scc1 Ld16
    s_sleep 4
    s_sub_u32 s93, s93, 1
    s_cmp_lg_u32 s93, 0
    s_cbranch_scc1 Lw15
Ld16:
    s_cmp_lg_u32 s16, 4
    s_cbranch_scc1 Lav17
    v_mov_b32 v168, 1536
    s_mov_b64 exec, 15
    ds_add_u32 v193, v168
    s_mov_b64 exec, -1
Lav17:
    s_branch Lc_k
Lh_ky:
Lb_load:
    s_and_b32 s28, s16, 3
    s_lshl_b32 s25, s28, 10
    s_add_u32 s25, s25, s99
    s_mov_b32 s4, s72
    s_mov_b32 s5, s73
    s_mov_b32 s6, 2359296
    s_mov_b32 s7, 0x20000
    s_mov_b32 m0, s25
    s_add_u32 s27, s25, 4096
    buffer_load_dwordx4 v184, s[4:7], 0 offen  lds
    s_mov_b32 m0, s27
    v_add_u32 v184, 36864, v184
    s_add_u32 s27, s99, 8192
    buffer_load_dwordx4 v184, s[4:7], 0 offen  lds
    s_mov_b32 m0, s27
    s_add_u32 s27, s25, 9216
    buffer_load_dwordx4 v186, s[4:7], 0 offen lds
    s_mov_b32 s4, s74
    s_mov_b32 s5, s75
    s_mov_b32 m0, s27
    s_add_u32 s27, s27, 4096
    buffer_load_dwordx4 v185, s[4:7], 0 offen  lds
    s_mov_b32 m0, s27
    s_mov_b32 s27, 36864
    buffer_load_dwordx4 v185, s[4:7], s27 offen  lds
    s_mov_b32 s4, s78
    s_mov_b32 s5, s79
    s_and_b32 s25, s28, 1
    s_lshl_b32 s25, s25, 11
    s_lshl_b32 s27, s98, 12
    s_add_u32 s27, s27, s25
    v_lshlrev_b32 v168, 3, v9
    s_mov_b64 exec, 0xffff
    buffer_load_dword v209, v168, s[4:7], s27 offen
    s_mov_b64 exec, -1
    s_cmp_eq_u32 s95, 1
    s_cbranch_scc1 Lb_setup2
    s_waitcnt vmcnt(6)
    v_mov_b32 v168, s3
    v_mov_b32 v169, 2
    ds_write_b32 v168, v169
    s_cmp_lg_u32 s16, 4
    s_cbranch_scc1 Lb_a6
    v_mov_b32 v172, s94
    s_mov_b32 s93, 200000
Lw18:
    ds_read_b128 v[168:171], v172
    s_waitcnt lgkmcnt(0)
    v_min_u32 v168, v168, v169
    v_min3_u32 v168, v168, v170, v171
    s_nop 0
    v_readfirstlane_b32 s92, v168
    s_cmp_ge_u32 s92, 2
    s_cbranch_scc1 Ld19
    s_sleep 1
    s_sub_u32 s93, s93, 1
    s_cmp_lg_u32 s93, 0
    s_cbranch_scc1 Lw18
Ld19:
    s_cmp_lg_u32 s16, 4
    s_cbranch_scc1 Lav20
    v_mov_b32 v168, 1536
    s_mov_b64 exec, 15
    ds_add_u32 v193, v168
    s_mov_b64 exec, -1
Lav20:
Lb_a6:
    s_waitcnt vmcnt(1)
Lb_s0:
    v_mov_b32 v168, s3
    v_mov_b32 v169, 3
    ds_write_b32 v168, v169
    v_mov_b32 v172, s94
    s_mov_b32 s93, 200000
Lw21:
    ds_read_b128 v[168:171], v172
    s_waitcnt lgkmcnt(0)
    v_min_u32 v168, v168, v169
    v_min3_u32 v168, v168, v170, v171
    s_nop 0
    v_readfirstlane_b32 s92, v168
    s_cmp_ge_u32 s92, 3
    s_cbranch_scc1 Ld22
    s_sleep 1
    s_sub_u32 s93, s93, 1
    s_cmp_lg_u32 s93, 0
    s_cbranch_scc1 Lw21
Ld22:
    ds_read_b128 v[40:43], v187 offset:0
    ds_read_b128 v[44:47], v187 offset:128
    ds_read_b128 v[48:51], v187 offset:256
    ds_read_b128 v[52:55], v187 offset:384
    ds_read_b128 v[56:59], v187 offset:512
    ds_read_b128 v[60:63], v187 offset:9216
    ds_read_b128 v[64:67], v187 offset:9344
    s_mov_b32 s29, 0xffff0000
    s_waitcnt lgkmcnt(2)
    v_dot2_f32_bf16 v84, v52, v216, 0
    v_dot2_f32_bf16 v85, v52, v217, 0
    v_dot2_f32_bf16 v86, v56, v216, 0
    v_dot2_f32_bf16 v87, v56, v217, 0
    v_dot2_f32_bf16 v88, v53, v224, 0
    v_dot2_f32_bf16 v89, v53, v225, 0
    v_dot2_f32_bf16 v90, v57, v224, 0
    v_dot2_f32_bf16 v91, v57, v225, 0
    v_dot2_f32_bf16 v92, v54, v232, 0
    v_dot2_f32_bf16 v93, v54, v233, 0
    v_dot2_f32_bf16 v94, v58, v232, 0
    v_dot2_f32_bf16 v95, v58, v233, 0
    v_dot2_f32_bf16 v96, v55, v240, 0
    v_dot2_f32_bf16 v97, v55, v241, 0
    v_dot2_f32_bf16 v98, v59, v240, 0
    v_dot2_f32_bf16 v99, v59, v241, 0
    v_dot2c_f32_bf16 v84, v48, v218
    v_dot2c_f32_bf16 v85, v48, v219
    v_dot2c_f32_bf16 v86, v52, v218
    v_dot2c_f32_bf16 v87, v52, v219
    v_dot2c_f32_bf16 v88, v49, v226
    v_dot2c_f32_bf16 v89, v49, v227
    v_dot2c_f32_bf16 v90, v53, v226
    v_dot2c_f32_bf16 v91, v53, v227
    v_dot2c_f32_bf16 v92, v50, v234
    v_dot2c_f32_bf16 v93, v50, v235
    v_dot2c_f32_bf16 v94, v54, v234
    v_dot2c_f32_bf16 v95, v54, v235
    v_dot2c_f32_bf16 v96, v51, v242
    v_dot2c_f32_bf16 v97, v51, v243
    v_dot2c_f32_bf16 v98, v55, v242
    v_dot2c_f32_bf16 v99, v55, v243
    v_dot2c_f32_bf16 v84, v44, v220
    v_dot2c_f32_bf16 v85, v44, v221
    v_dot2c_f32_bf16 v86, v48, v220
    v_dot2c_f32_bf16 v87, v48, v221
    v_dot2c_f32_bf16 v88, v45, v228
    v_dot2c_f32_bf16 v89, v45, v229
    v_dot2c_f32_bf16 v90, v49, v228
    v_dot2c_f32_bf16 v91, v49, v229
    v_dot2c_f32_bf16 v92, v46, v236
    v_dot2c_f32_bf16 v93, v46, v237
    v_dot2c_f32_bf16 v94, v50, v236
    v_dot2c_f32_bf16 v95, v50, v237
    v_dot2c_f32_bf16 v96, v47, v244
    v_dot2c_f32_bf16 v97, v47, v245
    v_dot2c_f32_bf16 v98, v51, v244
    v_dot2c_f32_bf16 v99, v51, v245
    v_dot2c_f32_bf16 v84, v40, v222
    v_dot2c_f32_bf16 v85, v40, v223
    v_dot2c_f32_bf16 v86, v44, v222
    v_dot2c_f32_bf16 v87, v44, v223
    v_dot2c_f32_bf16 v88, v41, v230
    v_dot2c_f32_bf16 v89, v41, v231
    v_dot2c_f32_bf16 v90, v45, v230
    v_dot2c_f32_bf16 v91, v45, v231
    v_dot2c_f32_bf16 v92, v42, v238
    v_dot2c_f32_bf16 v93, v42, v239
    v_dot2c_f32_bf16 v94, v46, v238
    v_dot2c_f32_bf16 v95, v46, v239
    v_dot2c_f32_bf16 v96, v43, v246
    v_dot2c_f32_bf16 v97, v43, v247
    v_dot2c_f32_bf16 v98, v47, v246
    v_dot2c_f32_bf16 v99, v47, v247
    s_waitcnt lgkmcnt(0)
    v_lshlrev_b32 v100, 16, v60
    v_and_b32 v101, s29, v60
    v_lshlrev_b32 v102, 16, v64
    v_and_b32 v103, s29, v64
    v_lshlrev_b32 v104, 16, v61
    v_and_b32 v105, s29, v61
    v_lshlrev_b32 v106, 16, v65
    v_and_b32 v107, s29, v65
    v_lshlrev_b32 v108, 16, v62
    v_and_b32 v109, s29, v62
    v_lshlrev_b32 v110, 16, v66
    v_and_b32 v111, s29, v66
    v_lshlrev_b32 v112, 16, v63
    v_and_b32 v113, s29, v63
    v_lshlrev_b32 v114, 16, v67
    v_and_b32 v115, s29, v67
    v_pk_mul_f32 v[84:85], v[84:85], v[100:101]
    v_pk_mul_f32 v[86:87], v[86:87], v[102:103]
    v_pk_mul_f32 v[88:89], v[88:89], v[104:105]
    v_pk_mul_f32 v[90:91], v[90:91], v[106:107]
    v_pk_mul_f32 v[92:93], v[92:93], v[108:109]
    v_pk_mul_f32 v[94:95], v[94:95], v[110:111]
    v_pk_mul_f32 v[96:97], v[96:97], v[112:113]
    v_pk_mul_f32 v[98:99], v[98:99], v[114:115]
    v_cvt_pk_bf16_f32 v136, v84, v85
    v_cvt_pk_bf16_f32 v140, v86, v87
    v_cvt_pk_bf16_f32 v137, v88, v89
    v_cvt_pk_bf16_f32 v141, v90, v91
    v_cvt_pk_bf16_f32 v138, v92, v93
    v_cvt_pk_bf16_f32 v142, v94, v95
    v_cvt_pk_bf16_f32 v139, v96, v97
    v_cvt_pk_bf16_f32 v143, v98, v99
    ds_write_b128 v187, v[136:139] offset:9216
    ds_write_b128 v187, v[140:143] offset:9344
    s_waitcnt lgkmcnt(0)
    v_mov_b32 v168, s3
    v_mov_b32 v169, 4
    ds_write_b32 v168, v169
    v_mov_b32 v172, s94
    s_mov_b32 s93, 200000
Lw23:
    ds_read_b128 v[168:171], v172
    s_waitcnt lgkmcnt(0)
    v_min_u32 v168, v168, v169
    v_min3_u32 v168, v168, v170, v171
    s_nop 0
    v_readfirstlane_b32 s92, v168
    s_cmp_ge_u32 s92, 4
    s_cbranch_scc1 Ld24
    s_sleep 1
    s_sub_u32 s93, s93, 1
    s_cmp_lg_u32 s93, 0
    s_cbranch_scc1 Lw23
Ld24:
    ds_read_b64_tr_b16 v[136:137], v188 offset:9216
    ds_read_b64_tr_b16 v[138:139], v188 offset:9728
    ds_read_b64_tr_b16 v[140:141], v188 offset:13312
    ds_read_b64_tr_b16 v[142:143], v188 offset:13824
    s_mov_b32 s27, 32768
    s_waitcnt lgkmcnt(0)
    ds_write_b128 v189, v[136:139]
    ds_write_b128 v189, v[140:143] offset:64
    ds_read_b128 v[144:147], v190
    ds_read_b128 v[148:151], v190 offset:1024
    s_waitcnt lgkmcnt(0)
    buffer_store_dwordx4 v[144:147], v191, s[12:15], 0 offen sc1
    buffer_store_dwordx4 v[148:151], v191, s[12:15], s27 offen sc1
    s_and_b32 s25, s16, 3
    s_cmp_lg_u32 s25, 0
    s_cbranch_scc1 Lb_nr
    s_cmp_eq_u32 s95, 0
    s_cbranch_scc1 Lb_nr
    v_and_b32 v169, 7, v0
    v_lshlrev_b32 v169, 2, v169
    s_mov_b32 s93, 200000
Lr25:
    global_load_dword v168, v169, s[84:85] sc1
    s_waitcnt vmcnt(0)
    v_cmp_eq_u32 vcc, 0, v168
    s_nop 3
    s_cmp_eq_u64 vcc, 0
    s_cbranch_scc1 Ld26
    s_sleep 2
    s_sub_u32 s93, s93, 1
    s_cmp_lg_u32 s93, 0
    s_cbranch_scc1 Lr25
Ld26:
Lb_nr:
    s_waitcnt vmcnt(0)
    v_mov_b32 v168, s3
    v_mov_b32 v169, 5
    ds_write_b32 v168, v169
    v_mov_b32 v172, s94
    s_mov_b32 s93, 200000
Lw27:
    ds_read_b128 v[168:171], v172
    s_waitcnt lgkmcnt(0)
    v_min_u32 v168, v168, v169
    v_min3_u32 v168, v168, v170, v171
    s_nop 0
    v_readfirstlane_b32 s92, v168
    s_cmp_ge_u32 s92, 5
    s_cbranch_scc1 Ld28
    s_sleep 1
    s_sub_u32 s93, s93, 1
    s_cmp_lg_u32 s93, 0
    s_cbranch_scc1 Lw27
Ld28:
    s_cmp_lt_u32 s16, 4
    s_cbranch_scc1 Lc_m
    s_cmp_eq_u32 s95, 1
    s_cbranch_scc1 Lc_x
Lc_m:
    s_and_b32 s25, s16, 3
    s_cmp_lg_u32 s25, 0
    s_cbranch_scc1 Lc_k0
    s_and_b32 s25, s2, 15
    s_add_u32 s25, s25, 64
    s_lshl_b32 s92, s25, 8
    s_add_u32 s92, s92, 16523264
    v_lshlrev_b32 v168, 15, v0
    v_mov_b32 v169, 1
    s_mov_b64 exec, 255
    buffer_atomic_add v169, v168, s[12:15], s92 offen sc1
    s_mov_b64 exec, -1
    s_cmp_lg_u32 s16, 0
    s_cbranch_scc1 Lc_k0
    v_mov_b32 v172, 161060
    s_mov_b32 s93, 200000
Lw29:
    ds_read_b32 v168, v172
    s_waitcnt lgkmcnt(0)
    v_readfirstlane_b32 s92, v168
    s_cmp_ge_u32 s92, 1
    s_cbranch_scc1 Ld30
    s_sleep 8
    s_sub_u32 s93, s93, 1
    s_cmp_lg_u32 s93, 0
    s_cbranch_scc1 Lw29
Ld30:
Lc_k0:
    s_cmp_lt_u32 s16, 4
    s_cbranch_scc1 Lattn
Lc_k:
    s_mov_b32 s31, 2
Ldm31:
    s_mov_b32 m0, s40
    s_add_u32 s46, s40, 4096
    buffer_load_dwordx4 v9, s[8:11], s40 offen sc1 lds
    s_mov_b32 m0, s46
    s_add_u32 s40, s40, 8192
    buffer_load_dwordx4 v9, s[8:11], s46 offen sc1 lds
    s_mov_b32 m0, s41
    s_add_u32 s46, s41, 4096
    buffer_load_dwordx4 v181, s[12:15], s43 offen sc1 lds
    s_mov_b32 m0, s46
    s_add_u32 s41, s41, 9216
    buffer_load_dwordx4 v182, s[12:15], s43 offen sc1 lds
    s_mov_b32 m0, s42
    s_add_u32 s43, s43, 294912
    buffer_load_dwordx4 v183, s[12:15], s44 offen sc1 lds
    s_add_u32 s42, s42, s45
    s_add_u32 s44, s44, s47
    s_sub_u32 s31, s31, 1
    s_cmp_lg_u32 s31, 0
    s_cbranch_scc1 Ldm31
    s_waitcnt vmcnt(0)
    v_mov_b32 v168, s3
    v_mov_b32 v169, 6
    ds_write_b32 v168, v169
    s_lshr_b32 s25, s2, 3
    s_lshl_b32 s25, s25, 2
    s_add_u32 s25, s25, s20
    s_mul_i32 s27, s25, 5248
    v_lshlrev_b32 v168, 7, v0
    v_add_u32 v169, s27, v168
    v_min_u32 v169, 663548, v169
    s_mov_b32 exec_hi, 0x1ff
    global_load_dword v210, v169, s[68:69]
    s_and_b32 s27, s2, 7
    s_mul_i32 s27, s27, 294912
    s_mul_i32 s25, s25, 2304
    s_add_u32 s27, s27, s25
    v_add_u32 v169, s27, v168
    s_mov_b64 exec, 0x3ffff
    global_load_dword v211, v169, s[70:71]
    s_mov_b64 exec, -1
    s_cmp_lg_u32 s16, 4
    s_cbranch_scc1 Lc_w
    v_mov_b32 v172, s94
    s_mov_b32 s93, 200000
Lw32:
    ds_read_b128 v[168:171], v172
    s_waitcnt lgkmcnt(0)
    v_min_u32 v168, v168, v169
    v_min3_u32 v168, v168, v170, v171
    s_nop 0
    v_readfirstlane_b32 s92, v168
    s_cmp_ge_u32 s92, 6
    s_cbranch_scc1 Ld33
    s_sleep 1
    s_sub_u32 s93, s93, 1
    s_cmp_lg_u32 s93, 0
    s_cbranch_scc1 Lw32
Ld33:
    s_cmp_lg_u32 s16, 4
    s_cbranch_scc1 Lav34
    v_mov_b32 v168, 1024
    s_mov_b64 exec, 15
    ds_add_u32 v193, v168
    s_mov_b64 exec, -1
Lav34:
    v_min_u32 v169, 15, v0
    v_add_u32 v169, 64, v169
    v_lshlrev_b32 v169, 8, v169
    s_mov_b32 s93, 200000
    s_and_b32 s92, s2, 7
    s_lshl_b32 s92, s92, 15
    s_add_u32 s92, s92, 16523264
    s_mov_b64 exec, 65535
Lp35:
    buffer_load_dword v168, v169, s[12:15], s92 offen sc1
    s_waitcnt vmcnt(0)
    v_cmp_le_u32 vcc, 16, v168
    s_nop 3
    s_cmp_eq_u64 vcc, exec
    s_cbranch_scc1 Ld36
    s_sleep 8
    s_sub_u32 s93, s93, 1
    s_cmp_lg_u32 s93, 0
    s_cbranch_scc1 Lp35
Ld36:
    s_mov_b64 exec, -1
    s_mov_b32 s93, 200000
Lq37:
    ds_read_b32 v168, v193
    s_waitcnt lgkmcnt(0)
    v_and_b32 v168, 0xff, v168
    v_cmp_gt_u32 vcc, 7, v168
    s_nop 3
    s_cmp_eq_u64 vcc, 0
    s_cbranch_scc1 Ld38
    s_sleep 4
    s_sub_u32 s93, s93, 1
    s_cmp_lg_u32 s93, 0
    s_cbranch_scc1 Lq37
Ld38:
    s_branch Lc_pd
Lc_x:
    s_cmp_lg_u32 s16, 4
    s_cbranch_scc1 Lc_w
    s_and_b32 s25, s2, 3
    s_add_u32 s25, s25, 80
    s_lshl_b32 s92, s25, 8
    s_add_u32 s92, s92, 16523264
    v_lshlrev_b32 v168, 15, v0
    v_mov_b32 v169, 1
    s_mov_b64 exec, 255
    buffer_atomic_add v169, v168, s[12:15], s92 offen sc1
    s_mov_b64 exec, -1
    v_min_u32 v169, 3, v0
    v_add_u32 v169, 80, v169
    v_lshlrev_b32 v169, 8, v169
    s_mov_b32 s93, 200000
    s_and_b32 s92, s2, 7
    s_lshl_b32 s92, s92, 15
    s_add_u32 s92, s92, 16523264
    s_mov_b64 exec, 15
Lp39:
    buffer_load_dword v168, v169, s[12:15], s92 offen sc1
    s_waitcnt vmcnt(0)
    v_cmp_le_u32 vcc, 8, v168
    s_nop 3
    s_cmp_eq_u64 vcc, exec
    s_cbranch_scc1 Ld40
    s_sleep 2
    s_sub_u32 s93, s93, 1
    s_cmp_lg_u32 s93, 0
    s_cbranch_scc1 Lp39
Ld40:
    s_mov_b64 exec, -1
Lc_pd:
    s_sub_u32 s25, 2, s95
    v_mov_b32 v168, 161060
    v_mov_b32 v169, s25
    ds_write_b32 v168, v169
Lc_w:
    s_sub_u32 s91, 2, s95
    v_mov_b32 v172, 161060
    s_mov_b32 s93, 200000
Lw41:
    ds_read_b32 v168, v172
    s_waitcnt lgkmcnt(0)
    v_readfirstlane_b32 s92, v168
    s_cmp_ge_u32 s92, s91
    s_cbranch_scc1 Ld42
    s_sleep 5
    s_sub_u32 s93, s93, 1
    s_cmp_lg_u32 s93, 0
    s_cbranch_scc1 Lw41
Ld42:
    s_and_b32 s28, s16, 1
    s_lshl_b32 s25, s28, 11
    s_add_u32 s27, s97, s25
    s_mov_b32 m0, s27
    s_lshl_b32 s27, s98, 12
    s_add_u32 s27, s27, s25
    buffer_load_dwordx4 v9, s[4:7], s27 offen lds
    buffer_load_dwordx4 v9, s[4:7], s27 offen offset:1024 lds
    ds_write_b128 v192, v[24:27]
    s_mul_i32 s25, s28, 8320
    s_add_u32 s25, s25, s96
    s_add_u32 s25, s25, 64
    s_lshl_b32 s27, s28, 2
    s_sub_u32 s27, s101, s27
    s_sub_u32 s27, s27, 2363392
    s_lshr_b32 s29, s98, 9
    s_lshl_b32 s29, s29, 12
    s_add_u32 s27, s27, s29
    s_mov_b32 m0, s25
    s_nop 0
    buffer_load_dwordx4 v9, s[12:15], s27 offen offset:0 sc1 lds
    buffer_load_dwordx4 v9, s[12:15], s27 offen offset:1024 sc1 lds
    buffer_load_dwordx4 v9, s[12:15], s27 offen offset:2048 sc1 lds
    buffer_load_dwordx4 v9, s[12:15], s27 offen offset:3072 sc1 lds
    s_add_u32 s25, s25, 4160
    s_sub_u32 s27, s27, 2
    s_mov_b32 m0, s25
    s_nop 0
    buffer_load_dwordx4 v9, s[12:15], s27 offen offset:0 sc1 lds
    buffer_load_dwordx4 v9, s[12:15], s27 offen offset:1024 sc1 lds
    buffer_load_dwordx4 v9, s[12:15], s27 offen offset:2048 sc1 lds
    buffer_load_dwordx4 v9, s[12:15], s27 offen offset:3072 sc1 lds
    s_waitcnt vmcnt(0) lgkmcnt(0)
    v_mov_b32 v168, s3
    v_mov_b32 v169, 17
    ds_write_b32 v168, v169
    v_mov_b32 v172, s94
    s_mov_b32 s93, 200000
Lw43:
    ds_read_b128 v[168:171], v172
    s_waitcnt lgkmcnt(0)
    v_min_u32 v168, v168, v169
    v_min3_u32 v168, v168, v170, v171
    s_nop 0
    v_readfirstlane_b32 s92, v168
    s_cmp_ge_u32 s92, 17
    s_cbranch_scc1 Ld44
    s_sleep 1
    s_sub_u32 s93, s93, 1
    s_cmp_lg_u32 s93, 0
    s_cbranch_scc1 Lw43
Ld44:
    s_setprio 0
    s_cmp_eq_u32 s28, 0
    s_cbranch_scc0 Lc_set1
    ds_read_b64_tr_b16 v[40:41], v16 offset:8
    ds_read_b64_tr_b16 v[42:43], v16 offset:0
    ds_read_b128 v[104:107], v17 offset:64
    ds_read_b64_tr_b16 v[44:45], v16 offset:520
    ds_read_b64_tr_b16 v[46:47], v16 offset:512
    ds_read_b128 v[108:111], v17 offset:576
    ds_read_b64_tr_b16 v[48:49], v16 offset:1032
    ds_read_b64_tr_b16 v[50:51], v16 offset:1024
    ds_read_b128 v[112:115], v17 offset:1088
    ds_read_b64_tr_b16 v[52:53], v16 offset:1544
    ds_read_b64_tr_b16 v[54:55], v16 offset:1536
    ds_read_b128 v[116:119], v17 offset:1600
    ds_read_b64_tr_b16 v[56:57], v16 offset:2056
    ds_read_b64_tr_b16 v[58:59], v16 offset:2048
    ds_read_b128 v[120:123], v17 offset:2112
    ds_read_b64_tr_b16 v[60:61], v16 offset:2568
    ds_read_b64_tr_b16 v[62:63], v16 offset:2560
    ds_read_b128 v[124:127], v17 offset:2624
    ds_read_b64_tr_b16 v[64:65], v16 offset:3080
    ds_read_b64_tr_b16 v[66:67], v16 offset:3072
    ds_read_b128 v[128:131], v17 offset:3136
    ds_read_b64_tr_b16 v[68:69], v16 offset:3592
    ds_read_b64_tr_b16 v[70:71], v16 offset:3584
    ds_read_b128 v[132:135], v17 offset:3648
    s_mov_b32 s31, 4
Lc_l0:
    s_waitcnt lgkmcnt(0)
    v_and_b32 v40, v20, v40
    v_and_b32 v41, v21, v41
    v_and_b32 v42, v22, v42
    v_and_b32 v43, v23, v43
    v_mov_b32 v20, -1
    v_mov_b32 v21, -1
    v_mov_b32 v22, -1
    v_mov_b32 v23, -1
    v_mfma_f32_16x16x32_bf16 v[24:27], v[40:43], v[104:107], v[24:27]
    ds_read_b64_tr_b16 v[72:73], v16 offset:72
    ds_read_b64_tr_b16 v[74:75], v16 offset:64
    v_mfma_f32_16x16x32_bf16 v[28:31], v[44:47], v[112:115], v[28:31]
    ds_read_b128 v[136:139], v17 offset:0
    ds_read_b64_tr_b16 v[76:77], v16 offset:584
    v_mfma_f32_16x16x32_bf16 v[28:31], v[48:51], v[108:111], v[28:31]
    ds_read_b64_tr_b16 v[78:79], v16 offset:576
    ds_read_b128 v[140:143], v17 offset:512
    v_mfma_f32_16x16x32_bf16 v[32:35], v[48:51], v[112:115], v[32:35]
    ds_read_b64_tr_b16 v[80:81], v16 offset:1096
    ds_read_b64_tr_b16 v[82:83], v16 offset:1088
    v_mfma_f32_16x16x32_bf16 v[28:31], v[40:43], v[116:119], v[28:31]
    ds_read_b128 v[144:147], v17 offset:1024
    ds_read_b64_tr_b16 v[84:85], v16 offset:1608
    v_mfma_f32_16x16x32_bf16 v[28:31], v[52:55], v[104:107], v[28:31]
    ds_read_b64_tr_b16 v[86:87], v16 offset:1600
    ds_read_b128 v[148:151], v17 offset:1536
    v_mfma_f32_16x16x32_bf16 v[32:35], v[44:47], v[116:119], v[32:35]
    ds_read_b64_tr_b16 v[88:89], v16 offset:2120
    ds_read_b64_tr_b16 v[90:91], v16 offset:2112
    v_mfma_f32_16x16x32_bf16 v[32:35], v[52:55], v[108:111], v[32:35]
    ds_read_b128 v[152:155], v17 offset:2048
    ds_read_b64_tr_b16 v[92:93], v16 offset:2632
    v_mfma_f32_16x16x32_bf16 v[32:35], v[40:43], v[120:123], v[32:35]
    ds_read_b64_tr_b16 v[94:95], v16 offset:2624
    ds_read_b128 v[156:159], v17 offset:2560
    v_mfma_f32_16x16x32_bf16 v[32:35], v[56:59], v[104:107], v[32:35]
    ds_read_b64_tr_b16 v[96:97], v16 offset:3144
    ds_read_b64_tr_b16 v[98:99], v16 offset:3136
    v_mfma_f32_16x16x32_bf16 v[36:39], v[52:55], v[120:123], v[36:39]
    ds_read_b128 v[160:163], v17 offset:3072
    ds_read_b64_tr_b16 v[100:101], v16 offset:3656
    v_mfma_f32_16x16x32_bf16 v[36:39], v[56:59], v[116:119], v[36:39]
    ds_read_b64_tr_b16 v[102:103], v16 offset:3648
    ds_read_b128 v[164:167], v17 offset:3584
    v_mfma_f32_16x16x32_bf16 v[36:39], v[48:51], v[124:127], v[36:39]
    v_mfma_f32_16x16x32_bf16 v[36:39], v[60:63], v[112:115], v[36:39]
    v_mfma_f32_16x16x32_bf16 v[36:39], v[44:47], v[128:131], v[36:39]
    v_mfma_f32_16x16x32_bf16 v[36:39], v[64:67], v[108:111], v[36:39]
    v_mfma_f32_16x16x32_bf16 v[36:39], v[40:43], v[132:135], v[36:39]
    v_mfma_f32_16x16x32_bf16 v[36:39], v[68:71], v[104:107], v[36:39]
    s_waitcnt lgkmcnt(0)
    v_add_u32 v16, 128, v16
    v_subrev_u32 v17, 128, v17
    v_mfma_f32_16x16x32_bf16 v[24:27], v[72:75], v[136:139], v[24:27]
    ds_read_b64_tr_b16 v[40:41], v16 offset:8
    ds_read_b64_tr_b16 v[42:43], v16 offset:0
    v_mfma_f32_16x16x32_bf16 v[28:31], v[76:79], v[144:147], v[28:31]
    ds_read_b128 v[104:107], v17 offset:64
    ds_read_b64_tr_b16 v[44:45], v16 offset:520
    v_mfma_f32_16x16x32_bf16 v[28:31], v[80:83], v[140:143], v[28:31]
    ds_read_b64_tr_b16 v[46:47], v16 offset:512
    ds_read_b128 v[108:111], v17 offset:576
    v_mfma_f32_16x16x32_bf16 v[32:35], v[80:83], v[144:147], v[32:35]
    ds_read_b64_tr_b16 v[48:49], v16 offset:1032
    ds_read_b64_tr_b16 v[50:51], v16 offset:1024
    v_mfma_f32_16x16x32_bf16 v[28:31], v[72:75], v[148:151], v[28:31]
    ds_read_b128 v[112:115], v17 offset:1088
    ds_read_b64_tr_b16 v[52:53], v16 offset:1544
    v_mfma_f32_16x16x32_bf16 v[28:31], v[84:87], v[136:139], v[28:31]
    ds_read_b64_tr_b16 v[54:55], v16 offset:1536
    ds_read_b128 v[116:119], v17 offset:1600
    v_mfma_f32_16x16x32_bf16 v[32:35], v[76:79], v[148:151], v[32:35]
    ds_read_b64_tr_b16 v[56:57], v16 offset:2056
    ds_read_b64_tr_b16 v[58:59], v16 offset:2048
    v_mfma_f32_16x16x32_bf16 v[32:35], v[84:87], v[140:143], v[32:35]
    ds_read_b128 v[120:123], v17 offset:2112
    ds_read_b64_tr_b16 v[60:61], v16 offset:2568
    v_mfma_f32_16x16x32_bf16 v[32:35], v[72:75], v[152:155], v[32:35]
    ds_read_b64_tr_b16 v[62:63], v16 offset:2560
    ds_read_b128 v[124:127], v17 offset:2624
    v_mfma_f32_16x16x32_bf16 v[32:35], v[88:91], v[136:139], v[32:35]
    ds_read_b64_tr_b16 v[64:65], v16 offset:3080
    ds_read_b64_tr_b16 v[66:67], v16 offset:3072
    v_mfma_f32_16x16x32_bf16 v[36:39], v[84:87], v[152:155], v[36:39]
    ds_read_b128 v[128:131], v17 offset:3136
    ds_read_b64_tr_b16 v[68:69], v16 offset:3592
    v_mfma_f32_16x16x32_bf16 v[36:39], v[88:91], v[148:151], v[36:39]
    ds_read_b64_tr_b16 v[70:71], v16 offset:3584
    ds_read_b128 v[132:135], v17 offset:3648
    v_mfma_f32_16x16x32_bf16 v[36:39], v[80:83], v[156:159], v[36:39]
    v_mfma_f32_16x16x32_bf16 v[36:39], v[92:95], v[144:147], v[36:39]
    v_mfma_f32_16x16x32_bf16 v[36:39], v[76:79], v[160:163], v[36:39]
    v_mfma_f32_16x16x32_bf16 v[36:39], v[96:99], v[140:143], v[36:39]
    v_mfma_f32_16x16x32_bf16 v[36:39], v[72:75], v[164:167], v[36:39]
    v_mfma_f32_16x16x32_bf16 v[36:39], v[100:103], v[136:139], v[36:39]
    s_sub_u32 s31, s31, 1
    s_cmp_lg_u32 s31, 0
    s_cbranch_scc1 Lc_l0
    s_waitcnt lgkmcnt(0)
    s_setprio 1
    v_add_u32 v19, s96, v18
    ds_read_b64 v[40:41], v19 offset:64
    ds_read_b64 v[42:43], v19 offset:1600
    ds_read_b64 v[44:45], v19 offset:2112
    ds_read_b64 v[46:47], v19 offset:3648
    s_waitcnt lgkmcnt(0)
    v_dot2c_f32_bf16 v24, v40, v194
    v_dot2c_f32_bf16 v25, v40, v195
    v_dot2c_f32_bf16 v26, v41, v194
    v_dot2c_f32_bf16 v27, v41, v195
    v_dot2c_f32_bf16 v28, v42, v194
    v_dot2c_f32_bf16 v29, v42, v195
    v_dot2c_f32_bf16 v30, v43, v194
    v_dot2c_f32_bf16 v31, v43, v195
    v_dot2c_f32_bf16 v32, v44, v194
    v_dot2c_f32_bf16 v33, v44, v195
    v_dot2c_f32_bf16 v34, v45, v194
    v_dot2c_f32_bf16 v35, v45, v195
    v_dot2c_f32_bf16 v36, v46, v194
    v_dot2c_f32_bf16 v37, v46, v195
    v_dot2c_f32_bf16 v38, v47, v194
    v_dot2c_f32_bf16 v39, v47, v195
    s_nop 1
    v_cvt_pk_bf16_f32 v104, v24, v25
    v_cvt_pk_bf16_f32 v105, v26, v27
    buffer_store_dwordx2 v[104:105], v18, s[12:15], s101 offen offset:0 sc1
    v_cvt_pk_bf16_f32 v106, v28, v29
    v_cvt_pk_bf16_f32 v107, v30, v31
    buffer_store_dwordx2 v[106:107], v18, s[12:15], s101 offen offset:1536 sc1
    v_cvt_pk_bf16_f32 v108, v32, v33
    v_cvt_pk_bf16_f32 v109, v34, v35
    buffer_store_dwordx2 v[108:109], v18, s[12:15], s101 offen offset:2048 sc1
    v_cvt_pk_bf16_f32 v110, v36, v37
    v_cvt_pk_bf16_f32 v111, v38, v39
    buffer_store_dwordx2 v[110:111], v18, s[12:15], s101 offen offset:3584 sc1
    s_branch Lc_done
Lc_set1:
    ds_read_b64_tr_b16 v[40:41], v16 offset:8
    ds_read_b64_tr_b16 v[42:43], v16 offset:0
    ds_read_b128 v[104:107], v17 offset:64
    ds_read_b64_tr_b16 v[44:45], v16 offset:520
    ds_read_b64_tr_b16 v[46:47], v16 offset:512
    ds_read_b128 v[108:111], v17 offset:576
    ds_read_b64_tr_b16 v[48:49], v16 offset:1032
    ds_read_b64_tr_b16 v[50:51], v16 offset:1024
    ds_read_b128 v[112:115], v17 offset:1088
    ds_read_b64_tr_b16 v[52:53], v16 offset:1544
    ds_read_b64_tr_b16 v[54:55], v16 offset:1536
    ds_read_b128 v[116:119], v17 offset:1600
    ds_read_b64_tr_b16 v[56:57], v16 offset:2056
    ds_read_b64_tr_b16 v[58:59], v16 offset:2048
    ds_read_b128 v[120:123], v17 offset:2112
    ds_read_b64_tr_b16 v[60:61], v16 offset:2568
    ds_read_b64_tr_b16 v[62:63], v16 offset:2560
    ds_read_b128 v[124:127], v17 offset:2624
    ds_read_b64_tr_b16 v[64:65], v16 offset:3080
    ds_read_b64_tr_b16 v[66:67], v16 offset:3072
    ds_read_b128 v[128:131], v17 offset:3136
    s_mov_b32 s31, 4
Lc_l1:
    s_waitcnt lgkmcnt(0)
    v_and_b32 v40, v20, v40
    v_and_b32 v41, v21, v41
    v_and_b32 v42, v22, v42
    v_and_b32 v43, v23, v43
    v_mov_b32 v20, -1
    v_mov_b32 v21, -1
    v_mov_b32 v22, -1
    v_mov_b32 v23, -1
    v_mfma_f32_16x16x32_bf16 v[24:27], v[40:43], v[108:111], v[24:27]
    ds_read_b64_tr_b16 v[72:73], v16 offset:72
    ds_read_b64_tr_b16 v[74:75], v16 offset:64
    v_mfma_f32_16x16x32_bf16 v[24:27], v[44:47], v[104:107], v[24:27]
    ds_read_b128 v[136:139], v17 offset:0
    ds_read_b64_tr_b16 v[76:77], v16 offset:584
    v_mfma_f32_16x16x32_bf16 v[28:31], v[44:47], v[108:111], v[28:31]
    ds_read_b64_tr_b16 v[78:79], v16 offset:576
    ds_read_b128 v[140:143], v17 offset:512
    v_mfma_f32_16x16x32_bf16 v[28:31], v[40:43], v[112:115], v[28:31]
    ds_read_b64_tr_b16 v[80:81], v16 offset:1096
    ds_read_b64_tr_b16 v[82:83], v16 offset:1088
    v_mfma_f32_16x16x32_bf16 v[28:31], v[48:51], v[104:107], v[28:31]
    ds_read_b128 v[144:147], v17 offset:1024
    ds_read_b64_tr_b16 v[84:85], v16 offset:1608
    v_mfma_f32_16x16x32_bf16 v[32:35], v[48:51], v[116:119], v[32:35]
    ds_read_b64_tr_b16 v[86:87], v16 offset:1600
    ds_read_b128 v[148:151], v17 offset:1536
    v_mfma_f32_16x16x32_bf16 v[32:35], v[52:55], v[112:115], v[32:35]
    ds_read_b64_tr_b16 v[88:89], v16 offset:2120
    ds_read_b64_tr_b16 v[90:91], v16 offset:2112
    v_mfma_f32_16x16x32_bf16 v[36:39], v[52:55], v[116:119], v[36:39]
    ds_read_b128 v[152:155], v17 offset:2048
    ds_read_b64_tr_b16 v[92:93], v16 offset:2632
    v_mfma_f32_16x16x32_bf16 v[32:35], v[44:47], v[120:123], v[32:35]
    ds_read_b64_tr_b16 v[94:95], v16 offset:2624
    ds_read_b128 v[156:159], v17 offset:2560
    v_mfma_f32_16x16x32_bf16 v[32:35], v[56:59], v[108:111], v[32:35]
    ds_read_b64_tr_b16 v[96:97], v16 offset:3144
    ds_read_b64_tr_b16 v[98:99], v16 offset:3136
    v_mfma_f32_16x16x32_bf16 v[36:39], v[48:51], v[120:123], v[36:39]
    ds_read_b128 v[160:163], v17 offset:3072
    v_mfma_f32_16x16x32_bf16 v[36:39], v[56:59], v[112:115], v[36:39]
    v_mfma_f32_16x16x32_bf16 v[32:35], v[40:43], v[124:127], v[32:35]
    v_mfma_f32_16x16x32_bf16 v[32:35], v[60:63], v[104:107], v[32:35]
    v_mfma_f32_16x16x32_bf16 v[36:39], v[44:47], v[124:127], v[36:39]
    v_mfma_f32_16x16x32_bf16 v[36:39], v[60:63], v[108:111], v[36:39]
    v_mfma_f32_16x16x32_bf16 v[36:39], v[40:43], v[128:131], v[36:39]
    v_mfma_f32_16x16x32_bf16 v[36:39], v[64:67], v[104:107], v[36:39]
    s_waitcnt lgkmcnt(0)
    v_add_u32 v16, 128, v16
    v_subrev_u32 v17, 128, v17
    v_mfma_f32_16x16x32_bf16 v[24:27], v[72:75], v[140:143], v[24:27]
    ds_read_b64_tr_b16 v[40:41], v16 offset:8
    ds_read_b64_tr_b16 v[42:43], v16 offset:0
    v_mfma_f32_16x16x32_bf16 v[24:27], v[76:79], v[136:139], v[24:27]
    ds_read_b128 v[104:107], v17 offset:64
    ds_read_b64_tr_b16 v[44:45], v16 offset:520
    v_mfma_f32_16x16x32_bf16 v[28:31], v[76:79], v[140:143], v[28:31]
    ds_read_b64_tr_b16 v[46:47], v16 offset:512
    ds_read_b128 v[108:111], v17 offset:576
    v_mfma_f32_16x16x32_bf16 v[28:31], v[72:75], v[144:147], v[28:31]
    ds_read_b64_tr_b16 v[48:49], v16 offset:1032
    ds_read_b64_tr_b16 v[50:51], v16 offset:1024
    v_mfma_f32_16x16x32_bf16 v[28:31], v[80:83], v[136:139], v[28:31]
    ds_read_b128 v[112:115], v17 offset:1088
    ds_read_b64_tr_b16 v[52:53], v16 offset:1544
    v_mfma_f32_16x16x32_bf16 v[32:35], v[80:83], v[148:151], v[32:35]
    ds_read_b64_tr_b16 v[54:55], v16 offset:1536
    ds_read_b128 v[116:119], v17 offset:1600
    v_mfma_f32_16x16x32_bf16 v[32:35], v[84:87], v[144:147], v[32:35]
    ds_read_b64_tr_b16 v[56:57], v16 offset:2056
    ds_read_b64_tr_b16 v[58:59], v16 offset:2048
    v_mfma_f32_16x16x32_bf16 v[36:39], v[84:87], v[148:151], v[36:39]
    ds_read_b128 v[120:123], v17 offset:2112
    ds_read_b64_tr_b16 v[60:61], v16 offset:2568
    v_mfma_f32_16x16x32_bf16 v[32:35], v[76:79], v[152:155], v[32:35]
    ds_read_b64_tr_b16 v[62:63], v16 offset:2560
    ds_read_b128 v[124:127], v17 offset:2624
    v_mfma_f32_16x16x32_bf16 v[32:35], v[88:91], v[140:143], v[32:35]
    ds_read_b64_tr_b16 v[64:65], v16 offset:3080
    ds_read_b64_tr_b16 v[66:67], v16 offset:3072
    v_mfma_f32_16x16x32_bf16 v[36:39], v[80:83], v[152:155], v[36:39]
    ds_read_b128 v[128:131], v17 offset:3136
    v_mfma_f32_16x16x32_bf16 v[36:39], v[88:91], v[144:147], v[36:39]
    v_mfma_f32_16x16x32_bf16 v[32:35], v[72:75], v[156:159], v[32:35]
    v_mfma_f32_16x16x32_bf16 v[32:35], v[92:95], v[136:139], v[32:35]
    v_mfma_f32_16x16x32_bf16 v[36:39], v[76:79], v[156:159], v[36:39]
    v_mfma_f32_16x16x32_bf16 v[36:39], v[92:95], v[140:143], v[36:39]
    v_mfma_f32_16x16x32_bf16 v[36:39], v[72:75], v[160:163], v[36:39]
    v_mfma_f32_16x16x32_bf16 v[36:39], v[96:99], v[136:139], v[36:39]
    s_sub_u32 s31, s31, 1
    s_cmp_lg_u32 s31, 0
    s_cbranch_scc1 Lc_l1
    s_waitcnt lgkmcnt(0)
    s_setprio 1
    v_add_u32 v19, s96, v18
    ds_read_b64 v[40:41], v19 offset:576
    ds_read_b64 v[42:43], v19 offset:1088
    ds_read_b64 v[44:45], v19 offset:2624
    ds_read_b64 v[46:47], v19 offset:3136
    s_waitcnt lgkmcnt(0)
    v_dot2c_f32_bf16 v24, v40, v194
    v_dot2c_f32_bf16 v25, v40, v195
    v_dot2c_f32_bf16 v26, v41, v194
    v_dot2c_f32_bf16 v27, v41, v195
    v_dot2c_f32_bf16 v28, v42, v194
    v_dot2c_f32_bf16 v29, v42, v195
    v_dot2c_f32_bf16 v30, v43, v194
    v_dot2c_f32_bf16 v31, v43, v195
    v_dot2c_f32_bf16 v32, v44, v194
    v_dot2c_f32_bf16 v33, v44, v195
    v_dot2c_f32_bf16 v34, v45, v194
    v_dot2c_f32_bf16 v35, v45, v195
    v_dot2c_f32_bf16 v36, v46, v194
    v_dot2c_f32_bf16 v37, v46, v195
    v_dot2c_f32_bf16 v38, v47, v194
    v_dot2c_f32_bf16 v39, v47, v195
    s_nop 1
    v_cvt_pk_bf16_f32 v104, v24, v25
    v_cvt_pk_bf16_f32 v105, v26, v27
    buffer_store_dwordx2 v[104:105], v18, s[12:15], s101 offen offset:512 sc1
    v_cvt_pk_bf16_f32 v106, v28, v29
    v_cvt_pk_bf16_f32 v107, v30, v31
    buffer_store_dwordx2 v[106:107], v18, s[12:15], s101 offen offset:1024 sc1
    v_cvt_pk_bf16_f32 v108, v32, v33
    v_cvt_pk_bf16_f32 v109, v34, v35
    buffer_store_dwordx2 v[108:109], v18, s[12:15], s101 offen offset:2560 sc1
    v_cvt_pk_bf16_f32 v110, v36, v37
    v_cvt_pk_bf16_f32 v111, v38, v39
    buffer_store_dwordx2 v[110:111], v18, s[12:15], s101 offen offset:3072 sc1
Lc_done:
    s_waitcnt vmcnt(0)
    v_mov_b32 v168, s3
    v_mov_b32 v169, 18
    ds_write_b32 v168, v169
    v_mov_b32 v172, s94
    s_mov_b32 s93, 200000
Lw45:
    ds_read_b128 v[168:171], v172
    s_waitcnt lgkmcnt(0)
    v_min_u32 v168, v168, v169
    v_min3_u32 v168, v168, v170, v171
    s_nop 0
    v_readfirstlane_b32 s92, v168
    s_cmp_ge_u32 s92, 18
    s_cbranch_scc1 Ld46
    s_sleep 1
    s_sub_u32 s93, s93, 1
    s_cmp_lg_u32 s93, 0
    s_cbranch_scc1 Lw45
Ld46:
    s_and_b32 s25, s16, 3
    s_cmp_lg_u32 s25, 0
    s_cbranch_scc1 Lc_e
    s_and_b32 s25, s2, 15
    s_add_u32 s25, s25, 16
    s_lshl_b32 s92, s25, 8
    s_add_u32 s92, s92, 16523264
    v_lshlrev_b32 v168, 15, v0
    v_mov_b32 v169, 1
    s_mov_b64 exec, 255
    buffer_atomic_add v169, v168, s[12:15], s92 offen sc1
    s_mov_b64 exec, -1
Lc_e:
    s_cmp_eq_u32 s95, 0
    s_cbranch_scc1 Lh_p3
    s_branch Lh_restart
Lattn:
    s_setprio 2
    s_and_b32 s17, s2, 7
    s_lshl_b32 s17, s17, 2
    s_bfe_u32 s25, s2, 0x20003
    s_add_u32 s17, s17, s25
    s_lshr_b32 s18, s2, 5
    s_and_b32 s20, s16, 3
    s_and_b32 s21, s17, 1
    s_lshr_b32 s26, s17, 1
    v_lshlrev_b32 v9, 4, v0
    s_mul_i32 s39, s26, 294912
    s_mul_i32 s28, s21, 139264
    s_add_u32 s27, s39, s28
    s_add_u32 s27, s27, 4718592
    s_add_u32 s8, s86, s27
    s_addc_u32 s9, s87, 0
    s_mov_b32 s10, 155648
    s_mov_b32 s11, 0x20000
    s_lshl_b32 s22, s21, 14
    s_add_u32 s23, s22, 65536
    s_cmp_eq_u32 s21, 0
    s_cselect_b32 s24, 139264, 0
    s_lshl_b32 s25, s20, 10
    s_add_u32 s40, s22, s25
    s_add_u32 s41, s23, s25
    s_add_u32 s42, s23, 8192
    s_and_b32 s44, s20, 1
    s_lshl_b32 s44, s44, 10
    s_add_u32 s44, s44, s24
    s_mul_i32 s43, s17, 288
    s_add_u32 s43, s43, 17571840
    s_add_u32 s46, s44, s27
    s_cmp_eq_u32 s20, 0
    s_cselect_b32 s42, s42, s44
    s_cselect_b32 s44, s43, s46
    s_cselect_b32 s45, 9, 2
    s_cselect_b32 s47, 288, 2
    s_cselect_b64 vcc, -1, 0
    s_lshl_b32 s45, s45, 10
    s_lshl_b32 s47, s47, 10
    s_lshl_b32 s25, s20, 6
    s_add_u32 s46, s25, 256
    v_add_u32 v5, s25, v0
    v_mul_u32_u24 v7, 3641, v5
    v_lshrrev_b32 v7, 16, v7
    v_mul_u32_u24 v8, 8928, v7
    v_lshl_add_u32 v181, v5, 4, v8
    v_add_u32 v5, s46, v0
    v_mul_u32_u24 v7, 3641, v5
    v_lshrrev_b32 v7, 16, v7
    v_mul_u32_u24 v8, 8928, v7
    v_lshl_add_u32 v182, v5, 4, v8
    v_add_u32 v5, 512, v0
    v_mul_u32_u24 v7, 3641, v5
    v_lshrrev_b32 v7, 16, v7
    v_mul_u32_u24 v8, 8928, v7
    v_lshl_add_u32 v183, v5, 4, v8
    v_cndmask_b32 v183, v9, v183, vcc
    v_lshlrev_b32 v1, 3, v0
    s_lshl_b32 s31, s18, 3
    s_lshl_b32 s32, s20, 1
    s_add_u32 s32, s31, s32
    s_mul_i32 s34, s21, 155648
    s_add_u32 s34, s34, s39
    s_lshl_b32 s35, s32, 10
    s_add_u32 s35, s35, s34
    s_add_u32 s34, s39, 139264
    s_lshl_b32 s37, s32, 8
    s_add_u32 s37, s37, s34
    v_and_b32 v6, 31, v0
    v_lshrrev_b32 v5, 5, v0
    v_mul_u32_u24 v8, 288, v5
    v_lshl_add_u32 v7, v6, 4, v8
    v_add_u32 v10, s23, v7
    v_mov_b32 v11, 4608
    v_mov_b32 v7, 155888
    v_mov_b32 v8, 155872
    v_cmp_eq_u32 vcc, 18, v6
    v_subrev_u32 v5, 20, v6
    v_cmp_gt_u32 s[52:53], 8, v5
    v_cndmask_b32 v7, v7, v8, vcc
    v_mov_b32 v8, 155824
    v_cmp_lt_u32 vcc, 17, v6
    v_cndmask_b32 v7, v7, v8, s[52:53]
    s_mov_b32 s50, 0
    v_cndmask_b32 v10, v10, v7, vcc
    v_cndmask_b32 v11, v11, 0, vcc
    v_cmp_gt_u32 vcc, 32, v0
    s_cmp_eq_u32 s21, 0
    s_cselect_b64 s[52:53], -1, 0
    s_cselect_b64 s[54:55], 0, -1
    s_and_b64 s[56:57], s[52:53], vcc
    s_and_b64 s[58:59], s[54:55], vcc
    s_andn2_b64 s[60:61], s[52:53], vcc
    s_andn2_b64 s[62:63], s[54:55], vcc
    v_lshlrev_b32 v7, 3, v6
    v_add_u32 v179, s22, v1
    v_add_u32 v180, s24, v1
    s_lshl_b32 s25, s20, 8
    s_add_u32 s25, s25, 160000
    v_lshlrev_b32 v176, 2, v0
    v_add_u32 v176, s25, v176
    v_mov_b32 v178, 2
    s_mul_i32 s25, s32, 36864
    s_add_u32 s25, s25, 9437184
    s_lshl_b32 s48, s17, 10
    s_add_u32 s48, s48, s25
    s_lshl_b32 s49, s17, 7
    s_add_u32 s49, s49, s25
    s_add_u32 s49, s49, 32768
    v_mov_b32 v108, 0
    v_mov_b32 v109, 0
    v_mov_b32 v110, 0
    v_mov_b32 v111, 0
    v_mov_b32 v112, 0
    v_mov_b32 v113, 0
    v_mov_b32 v114, 0
    v_mov_b32 v115, 0
    v_mov_b32 v116, 0
    v_mov_b32 v117, 0
    v_mov_b32 v118, 0
    v_mov_b32 v119, 0
    v_mov_b32 v120, 0
    v_mov_b32 v121, 0
    v_mov_b32 v122, 0
    v_mov_b32 v123, 0
    v_mov_b32 v124, 0
    v_mov_b32 v125, 0
    v_mov_b32 v126, 0
    v_mov_b32 v127, 0
    v_mov_b32 v128, 0
    v_mov_b32 v129, 0
    v_mov_b32 v130, 0
    v_mov_b32 v131, 0
    v_mov_b32 v132, 0
    v_mov_b32 v133, 0
    v_mov_b32 v134, 0
    v_mov_b32 v135, 0
    v_mov_b32 v136, 0
    v_mov_b32 v137, 0
    v_mov_b32 v138, 0
    v_mov_b32 v139, 0
    v_mov_b32 v100, 0
    v_mov_b32 v101, 0
    v_mov_b32 v102, 0
    v_mov_b32 v103, 0
    v_mov_b32 v104, 0
    v_mov_b32 v105, 0
    v_mov_b32 v106, 0
    v_mov_b32 v107, 0
    v_mov_b32 v160, 0
    v_mov_b32 v161, 0
    v_mov_b32 v162, 0
    v_mov_b32 v163, 0
    v_mov_b32 v164, 0
    v_mov_b32 v165, 0
    v_mov_b32 v166, 0
    v_mov_b32 v167, 0
    s_cmp_lg_u32 s16, 0
    s_cbranch_scc1 La_w
    s_mul_i32 s25, s26, 36
    s_mov_b64 s[28:29], 0
    s_lshr_b32 s27, s25, 7
    s_bitset1_b32 s28, s27
    s_add_u32 s27, s25, 35
    s_lshr_b32 s27, s27, 7
    s_bitset1_b32 s28, s27
    s_add_u32 s27, s25, 576
    s_lshr_b32 s27, s27, 7
    s_bitset1_b32 s28, s27
    s_add_u32 s27, s25, 611
    s_lshr_b32 s27, s27, 7
    s_bitset1_b32 s28, s27
    s_add_u32 s27, s25, 1152
    s_lshr_b32 s27, s27, 7
    s_bitset1_b32 s28, s27
    s_add_u32 s27, s25, 1187
    s_lshr_b32 s27, s27, 7
    s_bitset1_b32 s28, s27
    v_min_u32 v205, 13, v0
    v_add_u32 v205, 0, v205
    v_lshlrev_b32 v205, 8, v205
    s_mov_b32 s93, 200000
    s_and_b32 s92, s2, 7
    s_lshl_b32 s92, s92, 15
    s_add_u32 s92, s92, 16523264
    s_mov_b64 exec, s[28:29]
Lp47:
    buffer_load_dword v204, v205, s[12:15], s92 offen sc1
    s_waitcnt vmcnt(0)
    v_cmp_le_u32 vcc, 16, v204
    s_nop 3
    s_cmp_eq_u64 vcc, exec
    s_cbranch_scc1 Ld48
    s_sleep 2
    s_sub_u32 s93, s93, 1
    s_cmp_lg_u32 s93, 0
    s_cbranch_scc1 Lp47
Ld48:
    s_mov_b64 exec, -1
    v_mov_b32 v168, 161056
    v_mov_b32 v169, 1
    ds_write_b32 v168, v169
La_w:
    v_mov_b32 v172, 161056
    s_mov_b32 s93, 200000
Lw49:
    ds_read_b32 v168, v172
    s_waitcnt lgkmcnt(0)
    v_readfirstlane_b32 s92, v168
    s_cmp_ge_u32 s92, 1
    s_cbranch_scc1 Ld50
    s_sleep 1
    s_sub_u32 s93, s93, 1
    s_cmp_lg_u32 s93, 0
    s_cbranch_scc1 Lw49
Ld50:
    s_mov_b32 m0, s40
    s_add_u32 s46, s40, 4096
    buffer_load_dwordx4 v9, s[8:11], s40 offen sc1 lds
    s_mov_b32 m0, s46
    s_add_u32 s40, s40, 8192
    buffer_load_dwordx4 v9, s[8:11], s46 offen sc1 lds
    s_mov_b32 m0, s41
    s_add_u32 s46, s41, 4096
    buffer_load_dwordx4 v181, s[12:15], s43 offen sc1 lds
    s_mov_b32 m0, s46
    s_add_u32 s41, s41, 9216
    buffer_load_dwordx4 v182, s[12:15], s43 offen sc1 lds
    s_mov_b32 m0, s42
    s_add_u32 s43, s43, 294912
    buffer_load_dwordx4 v183, s[12:15], s44 offen sc1 lds
    s_add_u32 s42, s42, s45
    s_add_u32 s44, s44, s47
    buffer_load_dwordx2 v[12:13], v1, s[12:15], s35 offen sc1
    buffer_load_dwordx2 v[14:15], v1, s[12:15], s35 offen offset:512 sc1
    buffer_load_dwordx2 v[16:17], v1, s[12:15], s35 offen offset:1024 sc1
    buffer_load_dwordx2 v[18:19], v1, s[12:15], s35 offen offset:1536 sc1
    buffer_load_dwordx2 v[20:21], v7, s[12:15], s37 offen sc1
    buffer_load_dwordx2 v[24:25], v7, s[12:15], s37 offen offset:256 sc1
    s_cmp_lt_u32 s2, 224
    s_cbranch_scc1 La_n12
    s_mov_b32 s31, 2
Ldm51:
    s_mov_b32 m0, s40
    s_add_u32 s46, s40, 4096
    buffer_load_dwordx4 v9, s[8:11], s40 offen sc1 lds
    s_mov_b32 m0, s46
    s_add_u32 s40, s40, 8192
    buffer_load_dwordx4 v9, s[8:11], s46 offen sc1 lds
    s_mov_b32 m0, s41
    s_add_u32 s46, s41, 4096
    buffer_load_dwordx4 v181, s[12:15], s43 offen sc1 lds
    s_mov_b32 m0, s46
    s_add_u32 s41, s41, 9216
    buffer_load_dwordx4 v182, s[12:15], s43 offen sc1 lds
    s_mov_b32 m0, s42
    s_add_u32 s43, s43, 294912
    buffer_load_dwordx4 v183, s[12:15], s44 offen sc1 lds
    s_add_u32 s42, s42, s45
    s_add_u32 s44, s44, s47
    s_sub_u32 s31, s31, 1
    s_cmp_lg_u32 s31, 0
    s_cbranch_scc1 Ldm51
    s_mov_b32 s30, 1
    s_waitcnt vmcnt(10)
    s_branch La_n13
La_n12:
    s_mov_b32 s30, 0
    s_waitcnt vmcnt(0)
La_n13:
    v_mov_b32 v168, s3
    v_mov_b32 v169, 9
    ds_write_b32 v168, v169
    v_cndmask_b32 v22, 0, v20, s[60:61]
    v_cndmask_b32 v23, 0, v21, s[62:63]
    v_cndmask_b32 v20, 0, v20, s[56:57]
    v_cndmask_b32 v21, 0, v21, s[58:59]
    v_cndmask_b32 v26, 0, v24, s[60:61]
    v_cndmask_b32 v27, 0, v25, s[62:63]
    v_cndmask_b32 v24, 0, v24, s[56:57]
    v_cndmask_b32 v25, 0, v25, s[58:59]
    v_mov_b32 v172, 161024
    s_mov_b32 s93, 200000
Lw52:
    ds_read_b128 v[168:171], v172
    s_waitcnt lgkmcnt(0)
    v_min_u32 v168, v168, v169
    v_min3_u32 v168, v168, v170, v171
    s_nop 0
    v_readfirstlane_b32 s92, v168
    s_cmp_ge_u32 s92, 9
    s_cbranch_scc1 Ld53
    s_sleep 1
    s_sub_u32 s93, s93, 1
    s_cmp_lg_u32 s93, 0
    s_cbranch_scc1 Lw52
Ld53:
    ds_read2st64_b64 v[140:143], v179 offset0:0 offset1:1
    ds_read2st64_b64 v[148:151], v180 offset0:0 offset1:1
    s_waitcnt lgkmcnt(0)
    v_mfma_f32_32x32x16_bf16 v[60:75], v[140:143], v[12:15], 0
    v_mfma_f32_32x32x16_bf16 v[76:91], v[140:143], v[16:19], 0
    v_mfma_f32_32x32x8_bf16 v[60:75], v[148:149], v[20:21], v[60:75]
    v_mfma_f32_32x32x8_bf16 v[76:91], v[148:149], v[24:25], v[76:91]
    s_nop 10
    v_max3_f32 v5, v60, v61, v62
    v_max3_f32 v5, v63, v64, v5
    v_max3_f32 v5, v65, v66, v5
    v_max3_f32 v5, v67, v68, v5
    v_max3_f32 v5, v69, v70, v5
    v_max3_f32 v5, v71, v72, v5
    v_max3_f32 v5, v73, v74, v5
    v_max_f32 v5, v75, v5
    v_max3_f32 v6, v76, v77, v78
    v_max3_f32 v6, v79, v80, v6
    v_max3_f32 v6, v81, v82, v6
    v_max3_f32 v6, v83, v84, v6
    v_max3_f32 v6, v85, v86, v6
    v_max3_f32 v6, v87, v88, v6
    v_max3_f32 v6, v89, v90, v6
    v_max_f32 v6, v91, v6
La_setm:
    v_mov_b32 v7, v5
    v_mov_b32 v8, v6
    v_mov_b32 v2, v179
    v_mov_b32 v3, v180
    v_permlane32_swap_b32 v5, v7
    v_permlane32_swap_b32 v6, v8
    v_mov_b32 v4, v10
    ds_read_b128 v[152:155], v10
    ds_read_b128 v[156:159], v10 offset:576
    v_max_f32 v5, v5, v7
    v_max_f32 v6, v6, v8
    v_sub_f32 v28, 0, v5
    v_sub_f32 v29, 0, v5
    v_sub_f32 v30, 0, v5
    v_sub_f32 v31, 0, v5
    v_sub_f32 v32, 0, v5
    v_sub_f32 v33, 0, v5
    v_sub_f32 v34, 0, v5
    v_sub_f32 v35, 0, v5
    v_sub_f32 v36, 0, v5
    v_sub_f32 v37, 0, v5
    v_sub_f32 v38, 0, v5
    v_sub_f32 v39, 0, v5
    v_sub_f32 v40, 0, v5
    v_sub_f32 v41, 0, v5
    v_sub_f32 v42, 0, v5
    v_sub_f32 v43, 0, v5
    v_sub_f32 v44, 0, v6
    s_mov_b32 s51, 0
    v_mfma_f32_32x32x16_bf16 v[60:75], v[140:143], v[12:15], v[28:43]
    v_mfma_f32_32x32x8_bf16 v[60:75], v[148:149], v[20:21], v[60:75]
    v_sub_f32 v45, 0, v6
    v_sub_f32 v46, 0, v6
    v_sub_f32 v47, 0, v6
    v_sub_f32 v48, 0, v6
    v_sub_f32 v49, 0, v6
    v_sub_f32 v50, 0, v6
    v_sub_f32 v51, 0, v6
    v_sub_f32 v52, 0, v6
    v_sub_f32 v53, 0, v6
    v_sub_f32 v54, 0, v6
    v_sub_f32 v55, 0, v6
    v_sub_f32 v56, 0, v6
    v_sub_f32 v57, 0, v6
    v_sub_f32 v58, 0, v6
    v_sub_f32 v59, 0, v6
    s_setprio 0
.p2align 6
La_loop:
    v_mfma_f32_32x32x16_bf16 v[76:91], v[140:143], v[16:19], v[44:59]
    ds_read2st64_b64 v[144:147], v2 offset0:2 offset1:3
    v_exp_f32 v60, v60
    v_exp_f32 v61, v61
    v_exp_f32 v62, v62
    v_exp_f32 v63, v63
    v_cvt_pk_bf16_f32 v92, v60, v61
    v_cvt_pk_bf16_f32 v93, v62, v63
    v_mfma_f32_32x32x8_bf16 v[76:91], v[148:149], v[24:25], v[76:91]
    v_exp_f32 v64, v64
    v_exp_f32 v65, v65
    v_exp_f32 v66, v66
    v_exp_f32 v67, v67
    v_cvt_pk_bf16_f32 v94, v64, v65
    v_cvt_pk_bf16_f32 v95, v66, v67
    v_mfma_f32_32x32x16_bf16 v[124:139], v[160:163], v[100:103], v[124:139]
    s_min_u32 s53, s51, 12
    v_exp_f32 v68, v68
    v_exp_f32 v69, v69
    v_exp_f32 v70, v70
    v_exp_f32 v71, v71
    v_cvt_pk_bf16_f32 v96, v68, v69
    v_cvt_pk_bf16_f32 v97, v70, v71
    v_mfma_f32_32x32x16_bf16 v[124:139], v[164:167], v[104:107], v[124:139]
    s_waitcnt lgkmcnt(0)
    v_exp_f32 v72, v72
    v_exp_f32 v73, v73
    v_exp_f32 v74, v74
    v_exp_f32 v75, v75
    v_cvt_pk_bf16_f32 v98, v72, v73
    v_cvt_pk_bf16_f32 v99, v74, v75
    v_mfma_f32_32x32x16_bf16 v[60:75], v[144:147], v[12:15], v[28:43]
    s_add_u32 s51, s51, 2
    v_exp_f32 v76, v76
    v_exp_f32 v77, v77
    v_exp_f32 v78, v78
    v_exp_f32 v79, v79
    v_cvt_pk_bf16_f32 v100, v76, v77
    v_cvt_pk_bf16_f32 v101, v78, v79
    v_mfma_f32_32x32x8_bf16 v[60:75], v[148:149], v[22:23], v[60:75]
    v_exp_f32 v80, v80
    v_exp_f32 v81, v81
    v_exp_f32 v82, v82
    v_exp_f32 v83, v83
    v_cvt_pk_bf16_f32 v102, v80, v81
    v_cvt_pk_bf16_f32 v103, v82, v83
    v_mfma_f32_32x32x16_bf16 v[108:123], v[152:155], v[92:95], v[108:123]
    ds_read_b128 v[160:163], v4 offset:1152
    v_exp_f32 v84, v84
    v_exp_f32 v85, v85
    v_exp_f32 v86, v86
    v_exp_f32 v87, v87
    v_cvt_pk_bf16_f32 v104, v84, v85
    v_cvt_pk_bf16_f32 v105, v86, v87
    v_mfma_f32_32x32x16_bf16 v[108:123], v[156:159], v[96:99], v[108:123]
    ds_read_b128 v[164:167], v4 offset:1728
    v_exp_f32 v88, v88
    v_exp_f32 v89, v89
    v_exp_f32 v90, v90
    v_exp_f32 v91, v91
    v_cvt_pk_bf16_f32 v106, v88, v89
    v_cvt_pk_bf16_f32 v107, v90, v91
    v_mfma_f32_32x32x16_bf16 v[76:91], v[144:147], v[16:19], v[44:59]
    ds_read2st64_b64 v[140:143], v2 offset0:4 offset1:5
    ds_add_rtn_u32 v177, v176, v178
    v_exp_f32 v60, v60
    v_exp_f32 v61, v61
    v_exp_f32 v62, v62
    v_exp_f32 v63, v63
    v_cvt_pk_bf16_f32 v92, v60, v61
    v_cvt_pk_bf16_f32 v93, v62, v63
    v_mfma_f32_32x32x8_bf16 v[76:91], v[148:149], v[26:27], v[76:91]
    v_exp_f32 v64, v64
    v_exp_f32 v65, v65
    v_exp_f32 v66, v66
    v_exp_f32 v67, v67
    v_cvt_pk_bf16_f32 v94, v64, v65
    v_cvt_pk_bf16_f32 v95, v66, v67
    v_mfma_f32_32x32x16_bf16 v[124:139], v[152:155], v[100:103], v[124:139]
    v_exp_f32 v68, v68
    v_exp_f32 v69, v69
    v_exp_f32 v70, v70
    v_exp_f32 v71, v71
    v_cvt_pk_bf16_f32 v96, v68, v69
    v_cvt_pk_bf16_f32 v97, v70, v71
    v_mfma_f32_32x32x16_bf16 v[124:139], v[156:159], v[104:107], v[124:139]
    s_waitcnt lgkmcnt(0)
    v_exp_f32 v72, v72
    v_exp_f32 v73, v73
    v_exp_f32 v74, v74
    v_exp_f32 v75, v75
    v_cvt_pk_bf16_f32 v98, v72, v73
    v_cvt_pk_bf16_f32 v99, v74, v75
    v_mfma_f32_32x32x16_bf16 v[60:75], v[140:143], v[12:15], v[28:43]
    v_exp_f32 v76, v76
    v_exp_f32 v77, v77
    v_exp_f32 v78, v78
    v_exp_f32 v79, v79
    v_cvt_pk_bf16_f32 v100, v76, v77
    v_cvt_pk_bf16_f32 v101, v78, v79
    v_mfma_f32_32x32x8_bf16 v[60:75], v[150:151], v[20:21], v[60:75]
    v_readfirstlane_b32 s52, v177
    v_exp_f32 v80, v80
    v_exp_f32 v81, v81
    v_exp_f32 v82, v82
    v_exp_f32 v83, v83
    v_cvt_pk_bf16_f32 v102, v80, v81
    v_cvt_pk_bf16_f32 v103, v82, v83
    v_mfma_f32_32x32x16_bf16 v[108:123], v[160:163], v[92:95], v[108:123]
    ds_read_b128 v[152:155], v4 offset:2304
    v_exp_f32 v84, v84
    v_exp_f32 v85, v85
    v_exp_f32 v86, v86
    v_exp_f32 v87, v87
    v_cvt_pk_bf16_f32 v104, v84, v85
    v_cvt_pk_bf16_f32 v105, v86, v87
    v_mfma_f32_32x32x16_bf16 v[108:123], v[164:167], v[96:99], v[108:123]
    ds_read_b128 v[156:159], v4 offset:2880
    v_exp_f32 v88, v88
    v_exp_f32 v89, v89
    v_exp_f32 v90, v90
    v_exp_f32 v91, v91
    v_cvt_pk_bf16_f32 v106, v88, v89
    v_cvt_pk_bf16_f32 v107, v90, v91
    v_mfma_f32_32x32x16_bf16 v[76:91], v[140:143], v[16:19], v[44:59]
    ds_read2st64_b64 v[144:147], v2 offset0:6 offset1:7
    v_exp_f32 v60, v60
    v_exp_f32 v61, v61
    v_exp_f32 v62, v62
    v_exp_f32 v63, v63
    v_cvt_pk_bf16_f32 v92, v60, v61
    v_cvt_pk_bf16_f32 v93, v62, v63
    v_mfma_f32_32x32x8_bf16 v[76:91], v[150:151], v[24:25], v[76:91]
    v_exp_f32 v64, v64
    v_exp_f32 v65, v65
    v_exp_f32 v66, v66
    v_exp_f32 v67, v67
    v_cvt_pk_bf16_f32 v94, v64, v65
    v_cvt_pk_bf16_f32 v95, v66, v67
    v_mfma_f32_32x32x16_bf16 v[124:139], v[160:163], v[100:103], v[124:139]
    s_lshr_b32 s52, s52, 8
    v_exp_f32 v68, v68
    v_exp_f32 v69, v69
    v_exp_f32 v70, v70
    v_exp_f32 v71, v71
    v_cvt_pk_bf16_f32 v96, v68, v69
    v_cvt_pk_bf16_f32 v97, v70, v71
    v_mfma_f32_32x32x16_bf16 v[124:139], v[164:167], v[104:107], v[124:139]
    s_waitcnt lgkmcnt(0)
    v_exp_f32 v72, v72
    v_exp_f32 v73, v73
    v_exp_f32 v74, v74
    v_exp_f32 v75, v75
    v_cvt_pk_bf16_f32 v98, v72, v73
    v_cvt_pk_bf16_f32 v99, v74, v75
    v_mfma_f32_32x32x16_bf16 v[60:75], v[144:147], v[12:15], v[28:43]
    v_exp_f32 v76, v76
    v_exp_f32 v77, v77
    v_exp_f32 v78, v78
    v_exp_f32 v79, v79
    v_cvt_pk_bf16_f32 v100, v76, v77
    v_cvt_pk_bf16_f32 v101, v78, v79
    v_mfma_f32_32x32x8_bf16 v[60:75], v[150:151], v[22:23], v[60:75]
    v_exp_f32 v80, v80
    v_exp_f32 v81, v81
    v_exp_f32 v82, v82
    v_exp_f32 v83, v83
    v_cvt_pk_bf16_f32 v102, v80, v81
    v_cvt_pk_bf16_f32 v103, v82, v83
    v_mfma_f32_32x32x16_bf16 v[108:123], v[152:155], v[92:95], v[108:123]
    ds_read_b128 v[160:163], v4 offset:3456
    v_exp_f32 v84, v84
    v_exp_f32 v85, v85
    v_exp_f32 v86, v86
    v_exp_f32 v87, v87
    v_cvt_pk_bf16_f32 v104, v84, v85
    v_cvt_pk_bf16_f32 v105, v86, v87
    v_mfma_f32_32x32x16_bf16 v[108:123], v[156:159], v[96:99], v[108:123]
    ds_read_b128 v[164:167], v4 offset:4032
    v_exp_f32 v88, v88
    v_exp_f32 v89, v89
    v_exp_f32 v90, v90
    v_exp_f32 v91, v91
    v_cvt_pk_bf16_f32 v106, v88, v89
    v_cvt_pk_bf16_f32 v107, v90, v91
    v_mfma_f32_32x32x16_bf16 v[76:91], v[144:147], v[16:19], v[44:59]
    ds_read2st64_b64 v[140:143], v2 offset0:8 offset1:9
    ds_read2st64_b64 v[184:187], v3 offset0:2 offset1:3
    v_exp_f32 v60, v60
    v_exp_f32 v61, v61
    v_exp_f32 v62, v62
    v_exp_f32 v63, v63
    v_cvt_pk_bf16_f32 v92, v60, v61
    v_cvt_pk_bf16_f32 v93, v62, v63
    v_mfma_f32_32x32x8_bf16 v[76:91], v[150:151], v[26:27], v[76:91]
    v_add_u32 v4, v11, v4
    v_exp_f32 v64, v64
    v_exp_f32 v65, v65
    v_exp_f32 v66, v66
    v_exp_f32 v67, v67
    v_cvt_pk_bf16_f32 v94, v64, v65
    v_cvt_pk_bf16_f32 v95, v66, v67
    v_mfma_f32_32x32x16_bf16 v[124:139], v[152:155], v[100:103], v[124:139]
    v_exp_f32 v68, v68
    v_exp_f32 v69, v69
    v_exp_f32 v70, v70
    v_exp_f32 v71, v71
    v_cvt_pk_bf16_f32 v96, v68, v69
    v_cvt_pk_bf16_f32 v97, v70, v71
    v_mfma_f32_32x32x16_bf16 v[124:139], v[156:159], v[104:107], v[124:139]
    s_waitcnt lgkmcnt(0)
    v_exp_f32 v72, v72
    v_exp_f32 v73, v73
    v_exp_f32 v74, v74
    v_exp_f32 v75, v75
    v_cvt_pk_bf16_f32 v98, v72, v73
    v_cvt_pk_bf16_f32 v99, v74, v75
    v_mfma_f32_32x32x16_bf16 v[60:75], v[140:143], v[12:15], v[28:43]
    v_exp_f32 v76, v76
    v_exp_f32 v77, v77
    v_exp_f32 v78, v78
    v_exp_f32 v79, v79
    v_cvt_pk_bf16_f32 v100, v76, v77
    v_cvt_pk_bf16_f32 v101, v78, v79
    v_mfma_f32_32x32x8_bf16 v[60:75], v[184:185], v[20:21], v[60:75]
    v_exp_f32 v80, v80
    v_exp_f32 v81, v81
    v_exp_f32 v82, v82
    v_exp_f32 v83, v83
    v_cvt_pk_bf16_f32 v102, v80, v81
    v_cvt_pk_bf16_f32 v103, v82, v83
    v_mfma_f32_32x32x16_bf16 v[108:123], v[160:163], v[92:95], v[108:123]
    ds_read_b128 v[152:155], v4 offset:0
    v_exp_f32 v84, v84
    v_exp_f32 v85, v85
    v_exp_f32 v86, v86
    v_exp_f32 v87, v87
    v_cvt_pk_bf16_f32 v104, v84, v85
    v_cvt_pk_bf16_f32 v105, v86, v87
    v_mfma_f32_32x32x16_bf16 v[108:123], v[164:167], v[96:99], v[108:123]
    ds_read_b128 v[156:159], v4 offset:576
    v_exp_f32 v88, v88
    v_exp_f32 v89, v89
    v_exp_f32 v90, v90
    v_exp_f32 v91, v91
    v_cvt_pk_bf16_f32 v106, v88, v89
    v_cvt_pk_bf16_f32 v107, v90, v91
    v_mfma_f32_32x32x16_bf16 v[76:91], v[140:143], v[16:19], v[44:59]
    ds_read2st64_b64 v[144:147], v2 offset0:10 offset1:11
    v_exp_f32 v60, v60
    v_exp_f32 v61, v61
    v_exp_f32 v62, v62
    v_exp_f32 v63, v63
    v_cvt_pk_bf16_f32 v92, v60, v61
    v_cvt_pk_bf16_f32 v93, v62, v63
    v_mfma_f32_32x32x8_bf16 v[76:91], v[184:185], v[24:25], v[76:91]
    v_exp_f32 v64, v64
    v_exp_f32 v65, v65
    v_exp_f32 v66, v66
    v_exp_f32 v67, v67
    v_cvt_pk_bf16_f32 v94, v64, v65
    v_cvt_pk_bf16_f32 v95, v66, v67
    v_mfma_f32_32x32x16_bf16 v[124:139], v[160:163], v[100:103], v[124:139]
    v_exp_f32 v68, v68
    v_exp_f32 v69, v69
    v_exp_f32 v70, v70
    v_exp_f32 v71, v71
    v_cvt_pk_bf16_f32 v96, v68, v69
    v_cvt_pk_bf16_f32 v97, v70, v71
    v_mfma_f32_32x32x16_bf16 v[124:139], v[164:167], v[104:107], v[124:139]
    s_waitcnt lgkmcnt(0)
    v_exp_f32 v72, v72
    v_exp_f32 v73, v73
    v_exp_f32 v74, v74
    v_exp_f32 v75, v75
    v_cvt_pk_bf16_f32 v98, v72, v73
    v_cvt_pk_bf16_f32 v99, v74, v75
    v_mfma_f32_32x32x16_bf16 v[60:75], v[144:147], v[12:15], v[28:43]
    v_exp_f32 v76, v76
    v_exp_f32 v77, v77
    v_exp_f32 v78, v78
    v_exp_f32 v79, v79
    v_cvt_pk_bf16_f32 v100, v76, v77
    v_cvt_pk_bf16_f32 v101, v78, v79
    v_mfma_f32_32x32x8_bf16 v[60:75], v[184:185], v[22:23], v[60:75]
    v_exp_f32 v80, v80
    v_exp_f32 v81, v81
    v_exp_f32 v82, v82
    v_exp_f32 v83, v83
    v_cvt_pk_bf16_f32 v102, v80, v81
    v_cvt_pk_bf16_f32 v103, v82, v83
    v_mfma_f32_32x32x16_bf16 v[108:123], v[152:155], v[92:95], v[108:123]
    ds_read_b128 v[160:163], v4 offset:1152
    v_exp_f32 v84, v84
    v_exp_f32 v85, v85
    v_exp_f32 v86, v86
    v_exp_f32 v87, v87
    v_cvt_pk_bf16_f32 v104, v84, v85
    v_cvt_pk_bf16_f32 v105, v86, v87
    v_mfma_f32_32x32x16_bf16 v[108:123], v[156:159], v[96:99], v[108:123]
    ds_read_b128 v[164:167], v4 offset:1728
    v_exp_f32 v88, v88
    v_exp_f32 v89, v89
    v_exp_f32 v90, v90
    v_exp_f32 v91, v91
    v_cvt_pk_bf16_f32 v106, v88, v89
    v_cvt_pk_bf16_f32 v107, v90, v91
    v_mfma_f32_32x32x16_bf16 v[76:91], v[144:147], v[16:19], v[44:59]
    ds_read2st64_b64 v[140:143], v2 offset0:12 offset1:13
    v_exp_f32 v60, v60
    v_exp_f32 v61, v61
    v_exp_f32 v62, v62
    v_exp_f32 v63, v63
    v_cvt_pk_bf16_f32 v92, v60, v61
    v_cvt_pk_bf16_f32 v93, v62, v63
    v_mfma_f32_32x32x8_bf16 v[76:91], v[184:185], v[26:27], v[76:91]
    v_exp_f32 v64, v64
    v_exp_f32 v65, v65
    v_exp_f32 v66, v66
    v_exp_f32 v67, v67
    v_cvt_pk_bf16_f32 v94, v64, v65
    v_cvt_pk_bf16_f32 v95, v66, v67
    v_mfma_f32_32x32x16_bf16 v[124:139], v[152:155], v[100:103], v[124:139]
    v_exp_f32 v68, v68
    v_exp_f32 v69, v69
    v_exp_f32 v70, v70
    v_exp_f32 v71, v71
    v_cvt_pk_bf16_f32 v96, v68, v69
    v_cvt_pk_bf16_f32 v97, v70, v71
    v_mfma_f32_32x32x16_bf16 v[124:139], v[156:159], v[104:107], v[124:139]
    s_waitcnt lgkmcnt(0)
    v_exp_f32 v72, v72
    v_exp_f32 v73, v73
    v_exp_f32 v74, v74
    v_exp_f32 v75, v75
    v_cvt_pk_bf16_f32 v98, v72, v73
    v_cvt_pk_bf16_f32 v99, v74, v75
    v_mfma_f32_32x32x16_bf16 v[60:75], v[140:143], v[12:15], v[28:43]
    v_exp_f32 v76, v76
    v_exp_f32 v77, v77
    v_exp_f32 v78, v78
    v_exp_f32 v79, v79
    v_cvt_pk_bf16_f32 v100, v76, v77
    v_cvt_pk_bf16_f32 v101, v78, v79
    v_mfma_f32_32x32x8_bf16 v[60:75], v[186:187], v[20:21], v[60:75]
    v_exp_f32 v80, v80
    v_exp_f32 v81, v81
    v_exp_f32 v82, v82
    v_exp_f32 v83, v83
    v_cvt_pk_bf16_f32 v102, v80, v81
    v_cvt_pk_bf16_f32 v103, v82, v83
    v_mfma_f32_32x32x16_bf16 v[108:123], v[160:163], v[92:95], v[108:123]
    ds_read_b128 v[152:155], v4 offset:2304
    v_exp_f32 v84, v84
    v_exp_f32 v85, v85
    v_exp_f32 v86, v86
    v_exp_f32 v87, v87
    v_cvt_pk_bf16_f32 v104, v84, v85
    v_cvt_pk_bf16_f32 v105, v86, v87
    v_mfma_f32_32x32x16_bf16 v[108:123], v[164:167], v[96:99], v[108:123]
    ds_read_b128 v[156:159], v4 offset:2880
    v_exp_f32 v88, v88
    v_exp_f32 v89, v89
    v_exp_f32 v90, v90
    v_exp_f32 v91, v91
    v_cvt_pk_bf16_f32 v106, v88, v89
    v_cvt_pk_bf16_f32 v107, v90, v91
    v_mfma_f32_32x32x16_bf16 v[76:91], v[140:143], v[16:19], v[44:59]
    ds_read2st64_b64 v[144:147], v2 offset0:14 offset1:15
    v_exp_f32 v60, v60
    v_exp_f32 v61, v61
    v_exp_f32 v62, v62
    v_exp_f32 v63, v63
    v_cvt_pk_bf16_f32 v92, v60, v61
    v_cvt_pk_bf16_f32 v93, v62, v63
    v_mfma_f32_32x32x8_bf16 v[76:91], v[186:187], v[24:25], v[76:91]
    v_exp_f32 v64, v64
    v_exp_f32 v65, v65
    v_exp_f32 v66, v66
    v_exp_f32 v67, v67
    v_cvt_pk_bf16_f32 v94, v64, v65
    v_cvt_pk_bf16_f32 v95, v66, v67
    v_mfma_f32_32x32x16_bf16 v[124:139], v[160:163], v[100:103], v[124:139]
    v_exp_f32 v68, v68
    v_exp_f32 v69, v69
    v_exp_f32 v70, v70
    v_exp_f32 v71, v71
    v_cvt_pk_bf16_f32 v96, v68, v69
    v_cvt_pk_bf16_f32 v97, v70, v71
    v_mfma_f32_32x32x16_bf16 v[124:139], v[164:167], v[104:107], v[124:139]
    s_waitcnt lgkmcnt(0)
    v_exp_f32 v72, v72
    v_exp_f32 v73, v73
    v_exp_f32 v74, v74
    v_exp_f32 v75, v75
    v_cvt_pk_bf16_f32 v98, v72, v73
    v_cvt_pk_bf16_f32 v99, v74, v75
    v_mfma_f32_32x32x16_bf16 v[60:75], v[144:147], v[12:15], v[28:43]
    s_cmp_ge_u32 s53, s52
    v_exp_f32 v76, v76
    v_exp_f32 v77, v77
    v_exp_f32 v78, v78
    v_exp_f32 v79, v79
    v_cvt_pk_bf16_f32 v100, v76, v77
    v_cvt_pk_bf16_f32 v101, v78, v79
    v_mfma_f32_32x32x8_bf16 v[60:75], v[186:187], v[22:23], v[60:75]
    v_exp_f32 v80, v80
    v_exp_f32 v81, v81
    v_exp_f32 v82, v82
    v_exp_f32 v83, v83
    v_cvt_pk_bf16_f32 v102, v80, v81
    v_cvt_pk_bf16_f32 v103, v82, v83
    v_mfma_f32_32x32x16_bf16 v[108:123], v[152:155], v[92:95], v[108:123]
    ds_read_b128 v[160:163], v4 offset:3456
    v_exp_f32 v84, v84
    v_exp_f32 v85, v85
    v_exp_f32 v86, v86
    v_exp_f32 v87, v87
    v_cvt_pk_bf16_f32 v104, v84, v85
    v_cvt_pk_bf16_f32 v105, v86, v87
    v_mfma_f32_32x32x16_bf16 v[108:123], v[156:159], v[96:99], v[108:123]
    ds_read_b128 v[164:167], v4 offset:4032
    s_cbranch_scc1 La_chk
La_chkd:
    v_exp_f32 v88, v88
    v_exp_f32 v89, v89
    v_exp_f32 v90, v90
    v_exp_f32 v91, v91
    v_cvt_pk_bf16_f32 v106, v88, v89
    v_cvt_pk_bf16_f32 v107, v90, v91
    v_mfma_f32_32x32x16_bf16 v[76:91], v[144:147], v[16:19], v[44:59]
    ds_read2st64_b64 v[140:143], v2 offset0:16 offset1:17
    ds_read2st64_b64 v[148:151], v3 offset0:4 offset1:5
    v_exp_f32 v60, v60
    v_exp_f32 v61, v61
    v_exp_f32 v62, v62
    v_exp_f32 v63, v63
    v_cvt_pk_bf16_f32 v92, v60, v61
    v_cvt_pk_bf16_f32 v93, v62, v63
    v_mfma_f32_32x32x8_bf16 v[76:91], v[186:187], v[26:27], v[76:91]
    v_add_u32 v4, v11, v4
    v_exp_f32 v64, v64
    v_exp_f32 v65, v65
    v_exp_f32 v66, v66
    v_exp_f32 v67, v67
    v_cvt_pk_bf16_f32 v94, v64, v65
    v_cvt_pk_bf16_f32 v95, v66, v67
    v_mfma_f32_32x32x16_bf16 v[124:139], v[152:155], v[100:103], v[124:139]
    s_cmp_lt_u32 s51, 16
    v_exp_f32 v68, v68
    v_exp_f32 v69, v69
    v_exp_f32 v70, v70
    v_exp_f32 v71, v71
    v_cvt_pk_bf16_f32 v96, v68, v69
    v_cvt_pk_bf16_f32 v97, v70, v71
    v_mfma_f32_32x32x16_bf16 v[124:139], v[156:159], v[104:107], v[124:139]
    s_waitcnt lgkmcnt(0)
    v_exp_f32 v72, v72
    v_exp_f32 v73, v73
    v_exp_f32 v74, v74
    v_exp_f32 v75, v75
    v_cvt_pk_bf16_f32 v98, v72, v73
    v_cvt_pk_bf16_f32 v99, v74, v75
    v_mfma_f32_32x32x16_bf16 v[60:75], v[140:143], v[12:15], v[28:43]
    v_exp_f32 v76, v76
    v_exp_f32 v77, v77
    v_exp_f32 v78, v78
    v_exp_f32 v79, v79
    v_cvt_pk_bf16_f32 v100, v76, v77
    v_cvt_pk_bf16_f32 v101, v78, v79
    v_mfma_f32_32x32x8_bf16 v[60:75], v[148:149], v[20:21], v[60:75]
    v_add_u32 v2, 8192, v2
    v_add_u32 v3, 2048, v3
    v_exp_f32 v80, v80
    v_exp_f32 v81, v81
    v_exp_f32 v82, v82
    v_exp_f32 v83, v83
    v_cvt_pk_bf16_f32 v102, v80, v81
    v_cvt_pk_bf16_f32 v103, v82, v83
    v_mfma_f32_32x32x16_bf16 v[108:123], v[160:163], v[92:95], v[108:123]
    ds_read_b128 v[152:155], v4 offset:0
    v_exp_f32 v84, v84
    v_exp_f32 v85, v85
    v_exp_f32 v86, v86
    v_exp_f32 v87, v87
    v_cvt_pk_bf16_f32 v104, v84, v85
    v_cvt_pk_bf16_f32 v105, v86, v87
    v_mfma_f32_32x32x16_bf16 v[108:123], v[164:167], v[96:99], v[108:123]
    ds_read_b128 v[156:159], v4 offset:576
    v_exp_f32 v88, v88
    v_exp_f32 v89, v89
    v_exp_f32 v90, v90
    v_exp_f32 v91, v91
    v_cvt_pk_bf16_f32 v106, v88, v89
    v_cvt_pk_bf16_f32 v107, v90, v91
    s_cbranch_scc1 La_loop
    s_setprio 2
    v_mfma_f32_32x32x16_bf16 v[124:139], v[160:163], v[100:103], v[124:139]
    v_mfma_f32_32x32x16_bf16 v[124:139], v[164:167], v[104:107], v[124:139]
    v_lshlrev_b32 v7, 2, v0
    v_mov_b32 v8, 0
    v_mov_b32 v5, v118
    v_mov_b32 v6, v118
    v_add_f32 v8, |v108|, v8
    v_add_f32 v8, |v109|, v8
    v_add_f32 v8, |v110|, v8
    v_add_f32 v8, |v111|, v8
    v_add_f32 v8, |v112|, v8
    v_add_f32 v8, |v113|, v8
    v_add_f32 v8, |v114|, v8
    v_add_f32 v8, |v115|, v8
    v_add_f32 v8, |v116|, v8
    v_add_f32 v8, |v117|, v8
    v_add_f32 v8, |v118|, v8
    v_permlane32_swap_b32 v5, v6
    s_nop 1
    v_rcp_f32 v5, v5
    s_add_u32 s25, s48, 0
    s_add_u32 s27, s49, 0
    v_mul_f32 v108, v108, v5
    v_mul_f32 v109, v109, v5
    v_mul_f32 v110, v110, v5
    v_mul_f32 v111, v111, v5
    v_mul_f32 v112, v112, v5
    v_mul_f32 v113, v113, v5
    v_mul_f32 v114, v114, v5
    v_mul_f32 v115, v115, v5
    v_mul_f32 v116, v116, v5
    v_mul_f32 v117, v117, v5
    v_cvt_pk_bf16_f32 v92, v108, v109
    v_cvt_pk_bf16_f32 v93, v110, v111
    v_cvt_pk_bf16_f32 v94, v112, v113
    v_cvt_pk_bf16_f32 v95, v114, v115
    v_cvt_pk_bf16_f32 v96, v116, v117
    buffer_store_dwordx4 v[92:95], v9, s[12:15], s25 offen sc1
    s_mov_b32 exec_hi, 0
    buffer_store_dword v96, v7, s[12:15], s27 offen sc1
    s_mov_b32 exec_hi, -1
    v_mov_b32 v5, v134
    v_mov_b32 v6, v134
    v_add_f32 v8, |v124|, v8
    v_add_f32 v8, |v125|, v8
    v_add_f32 v8, |v126|, v8
    v_add_f32 v8, |v127|, v8
    v_add_f32 v8, |v128|, v8
    v_add_f32 v8, |v129|, v8
    v_add_f32 v8, |v130|, v8
    v_add_f32 v8, |v131|, v8
    v_add_f32 v8, |v132|, v8
    v_add_f32 v8, |v133|, v8
    v_add_f32 v8, |v134|, v8
    v_permlane32_swap_b32 v5, v6
    s_nop 1
    v_rcp_f32 v5, v5
    s_add_u32 s25, s48, 36864
    s_add_u32 s27, s49, 36864
    v_mul_f32 v124, v124, v5
    v_mul_f32 v125, v125, v5
    v_mul_f32 v126, v126, v5
    v_mul_f32 v127, v127, v5
    v_mul_f32 v128, v128, v5
    v_mul_f32 v129, v129, v5
    v_mul_f32 v130, v130, v5
    v_mul_f32 v131, v131, v5
    v_mul_f32 v132, v132, v5
    v_mul_f32 v133, v133, v5
    v_cvt_pk_bf16_f32 v100, v124, v125
    v_cvt_pk_bf16_f32 v101, v126, v127
    v_cvt_pk_bf16_f32 v102, v128, v129
    v_cvt_pk_bf16_f32 v103, v130, v131
    v_cvt_pk_bf16_f32 v104, v132, v133
    buffer_store_dwordx4 v[100:103], v9, s[12:15], s25 offen sc1
    s_mov_b32 exec_hi, 0
    buffer_store_dword v104, v7, s[12:15], s27 offen sc1
    s_mov_b32 exec_hi, -1
    v_mov_b32 v6, 0x71800000
    v_cmp_nlt_f32 vcc, v8, v6
    v_mov_b32 v8, 161064
    v_mov_b32 v7, 1
    s_cmp_lg_u32 s50, 0
    s_cbranch_scc1 Lp3
    s_cbranch_vccz Lp3
    ds_write_b32 v8, v7
    s_branch Lp3
La_chk:
    s_cmp_eq_u32 s30, 0
    s_cbranch_scc1 La_chk0
    s_mov_b32 s30, 0
    s_waitcnt vmcnt(0)
    v_mov_b32 v168, s3
    v_mov_b32 v169, 10
    ds_write_b32 v168, v169
    v_mov_b32 v172, s94
    s_mov_b32 s93, 200000
Lw54:
    ds_read_b128 v[168:171], v172
    s_waitcnt lgkmcnt(0)
    v_min_u32 v168, v168, v169
    v_min3_u32 v168, v168, v170, v171
    s_nop 0
    v_readfirstlane_b32 s92, v168
    s_cmp_ge_u32 s92, 10
    s_cbranch_scc1 Ld55
    s_sleep 1
    s_sub_u32 s93, s93, 1
    s_cmp_lg_u32 s93, 0
    s_cbranch_scc1 Lw54
Ld55:
    v_mov_b32 v168, 1024
    ds_add_u32 v176, v168
La_chk0:
    s_mov_b32 s93, 200000
La_chk1:
    ds_read_b32 v177, v176
    s_waitcnt lgkmcnt(0)
    v_readfirstlane_b32 s52, v177
    s_lshr_b32 s52, s52, 8
    s_cmp_lt_u32 s53, s52
    s_cbranch_scc1 La_chkd
    s_sleep 1
    s_sub_u32 s93, s93, 1
    s_cmp_lg_u32 s93, 0
    s_cbranch_scc1 La_chk1
    s_branch La_chkd
La_slow:
    s_mov_b32 s50, 1
    s_barrier
    v_mov_b32 v5, 3584
    ds_write_b32 v176, v5
    v_mov_b32 v8, 161064
    v_mov_b32 v7, 0
    ds_write_b32 v8, v7
    v_mov_b32 v2, v179
    v_mov_b32 v3, v180
    v_mov_b32 v5, 0xff800000
    v_mov_b32 v6, 0xff800000
    s_mov_b32 s51, 16
    s_waitcnt lgkmcnt(0)
    s_barrier
La_maxloop:
    ds_read2st64_b64 v[148:151], v3 offset0:0 offset1:1
    ds_read2st64_b64 v[140:143], v2 offset0:0 offset1:1
    s_waitcnt lgkmcnt(0)
    v_mfma_f32_32x32x16_bf16 v[60:75], v[140:143], v[12:15], 0
    v_mfma_f32_32x32x16_bf16 v[76:91], v[140:143], v[16:19], 0
    v_mfma_f32_32x32x8_bf16 v[60:75], v[148:149], v[20:21], v[60:75]
    v_mfma_f32_32x32x8_bf16 v[76:91], v[148:149], v[24:25], v[76:91]
    s_nop 11
    v_max3_f32 v5, v60, v61, v5
    v_max3_f32 v5, v62, v63, v5
    v_max3_f32 v5, v64, v65, v5
    v_max3_f32 v5, v66, v67, v5
    v_max3_f32 v5, v68, v69, v5
    v_max3_f32 v5, v70, v71, v5
    v_max3_f32 v5, v72, v73, v5
    v_max3_f32 v5, v74, v75, v5
    v_max3_f32 v6, v76, v77, v6
    v_max3_f32 v6, v78, v79, v6
    v_max3_f32 v6, v80, v81, v6
    v_max3_f32 v6, v82, v83, v6
    v_max3_f32 v6, v84, v85, v6
    v_max3_f32 v6, v86, v87, v6
    v_max3_f32 v6, v88, v89, v6
    v_max3_f32 v6, v90, v91, v6
    ds_read2st64_b64 v[140:143], v2 offset0:2 offset1:3
    s_waitcnt lgkmcnt(0)
    v_mfma_f32_32x32x16_bf16 v[60:75], v[140:143], v[12:15], 0
    v_mfma_f32_32x32x16_bf16 v[76:91], v[140:143], v[16:19], 0
    v_mfma_f32_32x32x8_bf16 v[60:75], v[148:149], v[22:23], v[60:75]
    v_mfma_f32_32x32x8_bf16 v[76:91], v[148:149], v[26:27], v[76:91]
    s_nop 11
    v_max3_f32 v5, v60, v61, v5
    v_max3_f32 v5, v62, v63, v5
    v_max3_f32 v5, v64, v65, v5
    v_max3_f32 v5, v66, v67, v5
    v_max3_f32 v5, v68, v69, v5
    v_max3_f32 v5, v70, v71, v5
    v_max3_f32 v5, v72, v73, v5
    v_max3_f32 v5, v74, v75, v5
    v_max3_f32 v6, v76, v77, v6
    v_max3_f32 v6, v78, v79, v6
    v_max3_f32 v6, v80, v81, v6
    v_max3_f32 v6, v82, v83, v6
    v_max3_f32 v6, v84, v85, v6
    v_max3_f32 v6, v86, v87, v6
    v_max3_f32 v6, v88, v89, v6
    v_max3_f32 v6, v90, v91, v6
    ds_read2st64_b64 v[140:143], v2 offset0:4 offset1:5
    s_waitcnt lgkmcnt(0)
    v_mfma_f32_32x32x16_bf16 v[60:75], v[140:143], v[12:15], 0
    v_mfma_f32_32x32x16_bf16 v[76:91], v[140:143], v[16:19], 0
    v_mfma_f32_32x32x8_bf16 v[60:75], v[150:151], v[20:21], v[60:75]
    v_mfma_f32_32x32x8_bf16 v[76:91], v[150:151], v[24:25], v[76:91]
    s_nop 11
    v_max3_f32 v5, v60, v61, v5
    v_max3_f32 v5, v62, v63, v5
    v_max3_f32 v5, v64, v65, v5
    v_max3_f32 v5, v66, v67, v5
    v_max3_f32 v5, v68, v69, v5
    v_max3_f32 v5, v70, v71, v5
    v_max3_f32 v5, v72, v73, v5
    v_max3_f32 v5, v74, v75, v5
    v_max3_f32 v6, v76, v77, v6
    v_max3_f32 v6, v78, v79, v6
    v_max3_f32 v6, v80, v81, v6
    v_max3_f32 v6, v82, v83, v6
    v_max3_f32 v6, v84, v85, v6
    v_max3_f32 v6, v86, v87, v6
    v_max3_f32 v6, v88, v89, v6
    v_max3_f32 v6, v90, v91, v6
    ds_read2st64_b64 v[140:143], v2 offset0:6 offset1:7
    s_waitcnt lgkmcnt(0)
    v_mfma_f32_32x32x16_bf16 v[60:75], v[140:143], v[12:15], 0
    v_mfma_f32_32x32x16_bf16 v[76:91], v[140:143], v[16:19], 0
    v_mfma_f32_32x32x8_bf16 v[60:75], v[150:151], v[22:23], v[60:75]
    v_mfma_f32_32x32x8_bf16 v[76:91], v[150:151], v[26:27], v[76:91]
    s_nop 11
    v_max3_f32 v5, v60, v61, v5
    v_max3_f32 v5, v62, v63, v5
    v_max3_f32 v5, v64, v65, v5
    v_max3_f32 v5, v66, v67, v5
    v_max3_f32 v5, v68, v69, v5
    v_max3_f32 v5, v70, v71, v5
    v_max3_f32 v5, v72, v73, v5
    v_max3_f32 v5, v74, v75, v5
    v_max3_f32 v6, v76, v77, v6
    v_max3_f32 v6, v78, v79, v6
    v_max3_f32 v6, v80, v81, v6
    v_max3_f32 v6, v82, v83, v6
    v_max3_f32 v6, v84, v85, v6
    v_max3_f32 v6, v86, v87, v6
    v_max3_f32 v6, v88, v89, v6
    v_max3_f32 v6, v90, v91, v6
    v_add_u32 v2, 4096, v2
    v_add_u32 v3, 1024, v3
    s_sub_u32 s51, s51, 1
    s_cmp_lg_u32 s51, 0
    s_cbranch_scc1 La_maxloop
    ds_read2st64_b64 v[140:143], v179 offset0:0 offset1:1
    ds_read2st64_b64 v[148:151], v180 offset0:0 offset1:1
    v_mov_b32 v108, 0
    v_mov_b32 v109, 0
    v_mov_b32 v110, 0
    v_mov_b32 v111, 0
    v_mov_b32 v112, 0
    v_mov_b32 v113, 0
    v_mov_b32 v114, 0
    v_mov_b32 v115, 0
    v_mov_b32 v116, 0
    v_mov_b32 v117, 0
    v_mov_b32 v118, 0
    v_mov_b32 v119, 0
    v_mov_b32 v120, 0
    v_mov_b32 v121, 0
    v_mov_b32 v122, 0
    v_mov_b32 v123, 0
    v_mov_b32 v124, 0
    v_mov_b32 v125, 0
    v_mov_b32 v126, 0
    v_mov_b32 v127, 0
    v_mov_b32 v128, 0
    v_mov_b32 v129, 0
    v_mov_b32 v130, 0
    v_mov_b32 v131, 0
    v_mov_b32 v132, 0
    v_mov_b32 v133, 0
    v_mov_b32 v134, 0
    v_mov_b32 v135, 0
    v_mov_b32 v136, 0
    v_mov_b32 v137, 0
    v_mov_b32 v138, 0
    v_mov_b32 v139, 0
    v_mov_b32 v100, 0
    v_mov_b32 v101, 0
    v_mov_b32 v102, 0
    v_mov_b32 v103, 0
    v_mov_b32 v104, 0
    v_mov_b32 v105, 0
    v_mov_b32 v106, 0
    v_mov_b32 v107, 0
    v_mov_b32 v160, 0
    v_mov_b32 v161, 0
    v_mov_b32 v162, 0
    v_mov_b32 v163, 0
    v_mov_b32 v164, 0
    v_mov_b32 v165, 0
    v_mov_b32 v166, 0
    v_mov_b32 v167, 0
    s_waitcnt lgkmcnt(0)
    s_branch La_setm
Lh_slow:
    s_barrier
    s_add_u32 s40, s40, 4294901760
    s_add_u32 s41, s41, 4294893568
    s_add_u32 s43, s43, 4292608000
    s_mul_i32 s25, s45, -8
    s_add_u32 s42, s42, s25
    s_mul_i32 s25, s47, -8
    s_add_u32 s44, s44, s25
    s_mov_b32 s31, 8
Ldm56:
    s_mov_b32 m0, s40
    s_add_u32 s46, s40, 4096
    buffer_load_dwordx4 v9, s[8:11], s40 offen sc1 lds
    s_mov_b32 m0, s46
    s_add_u32 s40, s40, 8192
    buffer_load_dwordx4 v9, s[8:11], s46 offen sc1 lds
    s_mov_b32 m0, s41
    s_add_u32 s46, s41, 4096
    buffer_load_dwordx4 v181, s[12:15], s43 offen sc1 lds
    s_mov_b32 m0, s46
    s_add_u32 s41, s41, 9216
    buffer_load_dwordx4 v182, s[12:15], s43 offen sc1 lds
    s_mov_b32 m0, s42
    s_add_u32 s43, s43, 294912
    buffer_load_dwordx4 v183, s[12:15], s44 offen sc1 lds
    s_add_u32 s42, s42, s45
    s_add_u32 s44, s44, s47
    s_sub_u32 s31, s31, 1
    s_cmp_lg_u32 s31, 0
    s_cbranch_scc1 Ldm56
    s_waitcnt vmcnt(0)
    s_barrier
Lh_p3:
    s_and_b32 s19, s2, 7
    s_lshr_b32 s33, s2, 3
    v_lshlrev_b32 v168, 7, v0
    s_cmp_ge_u32 s33, 24
    s_cbranch_scc0 Lh_wo
    s_branch Lp3
Lh_wo:
    s_mov_b32 s4, s68
    s_mov_b32 s5, s69
    s_mov_b32 s6, 663552
    s_mov_b32 s7, 0x20000
    v_add_u32 v1, 0, v0
    v_mul_u32_u24 v2, 5462, v1
    v_lshrrev_b32 v2, 16, v2
    v_mul_u32_u24 v3, 12, v2
    v_sub_u32 v1, v1, v3
    v_mul_u32_u24 v2, 1152, v2
    v_lshl_add_u32 v196, v1, 4, v2
    v_add_u32 v1, 64, v0
    v_mul_u32_u24 v2, 5462, v1
    v_lshrrev_b32 v2, 16, v2
    v_mul_u32_u24 v3, 12, v2
    v_sub_u32 v1, v1, v3
    v_mul_u32_u24 v2, 1152, v2
    v_lshl_add_u32 v197, v1, 4, v2
    v_add_u32 v1, 128, v0
    v_mul_u32_u24 v2, 5462, v1
    v_lshrrev_b32 v2, 16, v2
    v_mul_u32_u24 v3, 12, v2
    v_sub_u32 v1, v1, v3
    v_mul_u32_u24 v2, 1152, v2
    v_lshl_add_u32 v198, v1, 4, v2
    v_subrev_u32 v197, 1024, v197
    v_subrev_u32 v198, 2048, v198
    s_lshr_b32 s25, s33, 2
    s_mul_i32 s28, s25, 192
    s_mul_i32 s25, s20, 18432
    s_add_u32 s28, s28, s25
    s_mov_b32 s93, 200000
Lq57:
    ds_read_b32 v168, v193
    s_waitcnt lgkmcnt(0)
    v_and_b32 v168, 0xff, v168
    v_cmp_gt_u32 vcc, 13, v168
    s_nop 3
    s_cmp_eq_u64 vcc, 0
    s_cbranch_scc1 Ld58
    s_sleep 6
    s_sub_u32 s93, s93, 1
    s_cmp_lg_u32 s93, 0
    s_cbranch_scc1 Lq57
Ld58:
    s_add_u32 s27, s28, 0
    s_mul_i32 s25, s20, 3072
    s_add_u32 s25, s25, s23
    s_mov_b32 s31, s20
Lo_wo0:
    s_mov_b32 m0, s25
    s_add_u32 s31, s31, 4
    buffer_load_dwordx4 v196, s[4:7], s27 offen lds
    buffer_load_dwordx4 v197, s[4:7], s27 offen offset:1024 lds
    buffer_load_dwordx4 v198, s[4:7], s27 offen offset:2048 lds
    s_add_u32 s27, s27, 73728
    s_add_u32 s25, s25, 12288
    s_cmp_lt_u32 s31, 18
    s_cbranch_scc1 Lo_wo0
    s_mov_b32 s93, 200000
Lq59:
    ds_read_b32 v168, v193
    s_waitcnt lgkmcnt(0)
    v_and_b32 v168, 0xff, v168
    v_cmp_gt_u32 vcc, 15, v168
    s_nop 3
    s_cmp_eq_u64 vcc, 0
    s_cbranch_scc1 Ld60
    s_sleep 6
    s_sub_u32 s93, s93, 1
    s_cmp_lg_u32 s93, 0
    s_cbranch_scc1 Lq59
Ld60:
    s_add_u32 s27, s28, 331776
    s_mul_i32 s25, s20, 3072
    s_add_u32 s25, s25, s22
    s_mov_b32 s31, s20
Lo_wo1:
    s_mov_b32 m0, s25
    s_add_u32 s31, s31, 4
    buffer_load_dwordx4 v196, s[4:7], s27 offen lds
    buffer_load_dwordx4 v197, s[4:7], s27 offen offset:1024 lds
    buffer_load_dwordx4 v198, s[4:7], s27 offen offset:2048 lds
    s_add_u32 s27, s27, 73728
    s_add_u32 s25, s25, 12288
    s_cmp_lt_u32 s31, 18
    s_cbranch_scc1 Lo_wo1
Lp3:
    v_mov_b32 v169, 161064
    s_lshl_b32 s30, s18, 2
    s_lshr_b32 s25, s17, 3
    s_add_u32 s30, s30, s25
    s_add_u32 s30, s30, 32
    s_waitcnt vmcnt(0) lgkmcnt(0)
    s_barrier
    ds_read_b32 v168, v169
    s_and_b32 s19, s2, 7
    s_lshr_b32 s33, s2, 3
    s_waitcnt lgkmcnt(0)
    v_readfirstlane_b32 s25, v168
    s_cmp_eq_u32 s25, 0
    s_cbranch_scc1 Lp3_ok
    s_cmp_lt_u32 s16, 4
    s_cbranch_scc1 La_slow
    s_branch Lh_slow
Lp3_ok:
    s_cmp_lg_u32 s16, 7
    s_cbranch_scc1 Lp3_1
    s_lshl_b64 s[28:29], 1, s18
    s_lshl_b32 s92, s30, 8
    s_add_u32 s92, s92, 16523264
    v_lshlrev_b32 v14, 15, v0
    v_mov_b32 v15, 1
    s_mov_b64 exec, s[28:29]
    buffer_atomic_add v15, v14, s[12:15], s92 offen sc1
    s_mov_b64 exec, -1
Lp3_1:
    s_cmp_ge_u32 s33, 24
    s_cbranch_scc1 Lp3_s3
    s_and_b32 s17, s33, 3
    s_lshl_b32 s19, s19, 2
    s_add_u32 s17, s17, s19
    s_lshr_b32 s18, s33, 2
    s_mov_b32 s28, s23
    s_mov_b32 s29, s22
    s_and_b32 s23, s16, 1
    s_lshr_b32 s24, s16, 1
    v_lshlrev_b32 v12, 4, v0
    s_cmp_ge_u32 s16, 6
    s_cbranch_scc1 Lo_nopre
    v_lshrrev_b32 v1, 5, v0
    v_bfe_u32 v2, v0, 2, 2
    v_bfe_u32 v3, v0, 4, 1
    v_lshlrev_b32 v3, 5, v3
    v_and_b32 v7, 3, v0
    v_lshl_add_u32 v3, v7, 3, v3
    s_lshl_b32 s25, s24, 6
    v_add_u32 v3, s25, v3
    v_lshl_add_u32 v7, v1, 2, v2
    v_mul_u32_u24 v7, 192, v7
    v_add3_u32 v8, v7, v3, s28
    v_add3_u32 v9, v7, v3, s29
    v_mul_u32_u24 v7, 72, v1
    v_lshrrev_b32 v10, 1, v2
    v_mul_u32_u24 v10, 18, v10
    v_add_u32 v7, v7, v10
    v_and_b32 v10, 1, v2
    v_add3_u32 v7, v7, v10, 16
    v_mul_u32_u24 v7, 192, v7
    v_add3_u32 v10, v7, v3, s28
    v_add3_u32 v11, v7, v3, s29
    ds_read_b64_tr_b16 v[40:41], v8 offset:0
    ds_read_b64_tr_b16 v[42:43], v8 offset:1536
    ds_read_b64_tr_b16 v[44:45], v8 offset:3456
    ds_read_b64_tr_b16 v[46:47], v8 offset:4992
    ds_read_b64_tr_b16 v[48:49], v8 offset:6912
    ds_read_b64_tr_b16 v[50:51], v8 offset:8448
    ds_read_b64_tr_b16 v[52:53], v8 offset:10368
    ds_read_b64_tr_b16 v[54:55], v8 offset:11904
    ds_read_b64_tr_b16 v[56:57], v8 offset:13824
    ds_read_b64_tr_b16 v[58:59], v8 offset:15360
    ds_read_b64_tr_b16 v[60:61], v8 offset:17280
    ds_read_b64_tr_b16 v[62:63], v8 offset:18816
    s_waitcnt lgkmcnt(4)
    ds_read_b64_tr_b16 v[64:65], v8 offset:20736
    ds_read_b64_tr_b16 v[66:67], v8 offset:22272
    ds_read_b64_tr_b16 v[68:69], v8 offset:24192
    ds_read_b64_tr_b16 v[70:71], v8 offset:25728
    ds_read_b64_tr_b16 v[72:73], v8 offset:27648
    ds_read_b64_tr_b16 v[74:75], v8 offset:29184
    ds_read_b64_tr_b16 v[76:77], v8 offset:31104
    ds_read_b64_tr_b16 v[78:79], v8 offset:32640
    ds_read_b64_tr_b16 v[80:81], v8 offset:34560
    ds_read_b64_tr_b16 v[82:83], v8 offset:36096
    ds_read_b64_tr_b16 v[84:85], v8 offset:38016
    ds_read_b64_tr_b16 v[86:87], v8 offset:39552
    s_waitcnt lgkmcnt(4)
    ds_read_b64_tr_b16 v[88:89], v8 offset:41472
    ds_read_b64_tr_b16 v[90:91], v8 offset:43008
    ds_read_b64_tr_b16 v[92:93], v8 offset:44928
    ds_read_b64_tr_b16 v[94:95], v8 offset:46464
    ds_read_b64_tr_b16 v[96:97], v8 offset:48384
    ds_read_b64_tr_b16 v[98:99], v8 offset:49920
    ds_read_b64_tr_b16 v[100:101], v8 offset:51840
    ds_read_b64_tr_b16 v[102:103], v8 offset:53376
    ds_read_b64_tr_b16 v[104:105], v9 offset:0
    ds_read_b64_tr_b16 v[106:107], v9 offset:1536
    ds_read_b64_tr_b16 v[108:109], v9 offset:3456
    ds_read_b64_tr_b16 v[110:111], v9 offset:4992
    s_waitcnt lgkmcnt(4)
    ds_read_b64_tr_b16 v[112:113], v9 offset:6912
    ds_read_b64_tr_b16 v[114:115], v9 offset:8448
    ds_read_b64_tr_b16 v[116:117], v9 offset:10368
    ds_read_b64_tr_b16 v[118:119], v9 offset:11904
    ds_read_b64_tr_b16 v[120:121], v9 offset:13824
    ds_read_b64_tr_b16 v[122:123], v9 offset:15360
    ds_read_b64_tr_b16 v[124:125], v9 offset:17280
    ds_read_b64_tr_b16 v[126:127], v9 offset:18816
    ds_read_b64_tr_b16 v[128:129], v9 offset:20736
    ds_read_b64_tr_b16 v[130:131], v9 offset:22272
    ds_read_b64_tr_b16 v[132:133], v9 offset:24192
    ds_read_b64_tr_b16 v[134:135], v9 offset:25728
    s_waitcnt lgkmcnt(4)
    ds_read_b64_tr_b16 v[136:137], v9 offset:27648
    ds_read_b64_tr_b16 v[138:139], v9 offset:29184
    ds_read_b64_tr_b16 v[140:141], v9 offset:31104
    ds_read_b64_tr_b16 v[142:143], v9 offset:32640
    ds_read_b64_tr_b16 v[144:145], v9 offset:34560
    ds_read_b64_tr_b16 v[146:147], v9 offset:36096
    ds_read_b64_tr_b16 v[148:149], v9 offset:38016
    ds_read_b64_tr_b16 v[150:151], v9 offset:39552
    ds_read_b64_tr_b16 v[152:153], v9 offset:41472
    ds_read_b64_tr_b16 v[154:155], v9 offset:43008
    ds_read_b64_tr_b16 v[156:157], v9 offset:44928
    ds_read_b64_tr_b16 v[158:159], v9 offset:46464
    s_waitcnt lgkmcnt(4)
    ds_read_b64_tr_b16 v[160:161], v9 offset:48384
    ds_read_b64_tr_b16 v[162:163], v9 offset:49920
    ds_read_b64_tr_b16 v[164:165], v9 offset:51840
    ds_read_b64_tr_b16 v[166:167], v9 offset:53376
    ds_read_b64_tr_b16 v[168:169], v10 offset:0
    ds_read_b64_tr_b16 v[170:171], v10 offset:6912
    ds_read_b64_tr_b16 v[172:173], v10 offset:27648
    ds_read_b64_tr_b16 v[174:175], v10 offset:34560
    ds_read_b64_tr_b16 v[176:177], v11 offset:0
    ds_read_b64_tr_b16 v[178:179], v11 offset:6912
    ds_read_b64_tr_b16 v[180:181], v11 offset:27648
    ds_read_b64_tr_b16 v[182:183], v11 offset:34560
    s_waitcnt lgkmcnt(4)
Lo_nopre:
    s_mov_b32 s44, s82
    s_mov_b32 s45, s83
    s_mov_b32 s46, 4718592
    s_mov_b32 s47, 0x20000
    v_mov_b32 v184, 0
    v_mov_b32 v185, 0
    v_mov_b32 v186, 0
    v_mov_b32 v187, 0
    v_mov_b32 v188, 0
    v_mov_b32 v189, 0
    v_mov_b32 v190, 0
    v_mov_b32 v191, 0
    v_mov_b32 v192, 0
    v_mov_b32 v193, 0
    v_mov_b32 v194, 0
    v_mov_b32 v195, 0
    v_mov_b32 v196, 0
    v_mov_b32 v197, 0
    v_mov_b32 v198, 0
    v_mov_b32 v199, 0
    s_mul_i32 s20, s17, 73728
    s_add_u32 s20, s20, 9437184
    s_mul_i32 s21, s23, 36864
    s_add_u32 s20, s20, s21
    s_lshl_b32 s21, s24, 10
    s_add_u32 s20, s20, s21
    s_lshl_b32 s21, s23, 10
    v_add_u32 v13, s21, v12
    v_and_b32 v1, 31, v0
    v_lshlrev_b32 v1, 2, v1
    v_lshrrev_b32 v2, 5, v0
    v_lshl_add_u32 v1, v2, 9, v1
    s_add_u32 s21, s21, 65536
    v_add_u32 v201, s21, v1
    v_add_u32 v202, 2048, v201
    v_add_u32 v203, 4096, v201
    v_add_u32 v204, 6144, v201
    v_and_b32 v1, 31, v0
    s_lshl_b32 s21, s23, 5
    v_add_u32 v1, s21, v1
    v_mul_u32_u24 v1, 208, v1
    v_lshl_add_u32 v1, v2, 3, v1
    s_lshl_b32 s21, s24, 6
    s_add_u32 s21, s21, 81920
    v_add_u32 v200, s21, v1
    s_mul_i32 s26, s17, 147456
    s_mul_i32 s22, s18, 192
    s_add_u32 s26, s26, s22
    s_lshl_b32 s22, s16, 7
    v_add_u32 v1, s22, v0
    v_add_u32 v1, 0, v1
    v_mul_u32_u24 v2, 5462, v1
    v_lshrrev_b32 v2, 16, v2
    v_mul_u32_u24 v3, 12, v2
    v_sub_u32 v1, v1, v3
    v_lshlrev_b32 v1, 4, v1
    v_mul_u32_u24 v3, 208, v2
    v_add_u32 v4, v3, v1
    v_add_u32 v4, 81920, v4
    v_mul_u32_u24 v3, 2304, v2
    v_add_u32 v6, v3, v1
    v_add_u32 v1, s22, v0
    v_add_u32 v1, 64, v1
    v_mul_u32_u24 v2, 5462, v1
    v_lshrrev_b32 v2, 16, v2
    v_mul_u32_u24 v3, 12, v2
    v_sub_u32 v1, v1, v3
    v_lshlrev_b32 v1, 4, v1
    v_mul_u32_u24 v3, 208, v2
    v_add_u32 v5, v3, v1
    v_add_u32 v5, 81920, v5
    v_mul_u32_u24 v3, 2304, v2
    v_add_u32 v7, v3, v1
    s_lshl_b32 s21, s16, 10
    s_waitcnt lgkmcnt(0)
    s_cmp_lg_u32 s16, 7
    s_cbranch_scc1 Lp3_h
    s_add_u32 s25, s19, 32
    v_min_u32 v209, 3, v0
    v_add_u32 v209, s25, v209
    v_lshlrev_b32 v209, 8, v209
    s_mov_b32 s93, 200000
    s_and_b32 s92, s2, 7
    s_lshl_b32 s92, s92, 15
    s_add_u32 s92, s92, 16523264
    s_mov_b64 exec, 15
Lp61:
    buffer_load_dword v208, v209, s[12:15], s92 offen sc1
    s_waitcnt vmcnt(0)
    v_cmp_le_u32 vcc, 8, v208
    s_nop 3
    s_cmp_eq_u64 vcc, exec
    s_cbranch_scc1 Ld62
    s_sleep 2
    s_sub_u32 s93, s93, 1
    s_cmp_lg_u32 s93, 0
    s_cbranch_scc1 Lp61
Ld62:
    s_mov_b64 exec, -1
Lp3_h:
    s_barrier
    s_mov_b32 m0, s21
    s_add_u32 s21, s21, 8192
    buffer_load_dwordx4 v12, s[12:15], s20 offen sc1 lds
    s_add_u32 s20, s20, 4096
    s_mov_b32 m0, s21
    s_add_u32 s21, s21, 8192
    buffer_load_dwordx4 v12, s[12:15], s20 offen sc1 lds
    s_add_u32 s20, s20, 4096
    s_mov_b32 m0, s21
    s_add_u32 s21, s21, 8192
    buffer_load_dwordx4 v12, s[12:15], s20 offen sc1 lds
    s_add_u32 s20, s20, 4096
    s_mov_b32 m0, s21
    s_add_u32 s21, s21, 8192
    buffer_load_dwordx4 v12, s[12:15], s20 offen sc1 lds
    s_add_u32 s20, s20, 4096
    s_mov_b32 m0, s21
    s_add_u32 s21, s21, 8192
    buffer_load_dwordx4 v12, s[12:15], s20 offen sc1 lds
    s_add_u32 s20, s20, 4096
    s_mov_b32 m0, s21
    s_add_u32 s21, s21, 8192
    buffer_load_dwordx4 v12, s[12:15], s20 offen sc1 lds
    s_add_u32 s20, s20, 4096
    s_mov_b32 m0, s21
    s_add_u32 s21, s21, 8192
    buffer_load_dwordx4 v12, s[12:15], s20 offen sc1 lds
    s_add_u32 s20, s20, 4096
    s_mov_b32 m0, s21
    s_add_u32 s21, s21, 8192
    buffer_load_dwordx4 v12, s[12:15], s20 offen sc1 lds
    s_add_u32 s20, s20, 4096
    s_mov_b32 m0, s21
    s_add_u32 s21, s21, 8192
    buffer_load_dwordx4 v12, s[12:15], s20 offen sc1 lds
    s_add_u32 s20, s20, 4096
    v_add_u32 v14, 49152, v13
    s_waitcnt vmcnt(6)
    s_barrier
    s_cmp_ge_u32 s16, 6
    s_cbranch_scc1 Lo_idle
    ds_read_b128 v[16:19], v13 offset:0
    ds_read_b128 v[20:23], v13 offset:2048
    ds_read_b128 v[24:27], v13 offset:4096
    ds_read_b128 v[28:31], v13 offset:6144
    ds_read_b128 v[32:35], v13 offset:8192
    ds_read_b128 v[36:39], v13 offset:10240
    s_waitcnt lgkmcnt(5)
    v_mfma_f32_32x32x16_bf16 v[184:199], v[40:43], v[16:19], v[184:199]
    ds_read_b128 v[216:219], v13 offset:12288
    s_waitcnt lgkmcnt(5)
    v_mfma_f32_32x32x16_bf16 v[184:199], v[44:47], v[20:23], v[184:199]
    ds_read_b128 v[220:223], v13 offset:14336
    s_waitcnt lgkmcnt(5)
    v_mfma_f32_32x32x16_bf16 v[184:199], v[48:51], v[24:27], v[184:199]
    ds_read_b128 v[224:227], v13 offset:16384
    s_waitcnt lgkmcnt(5)
    v_mfma_f32_32x32x16_bf16 v[184:199], v[52:55], v[28:31], v[184:199]
    ds_read_b128 v[228:231], v13 offset:18432
    s_waitcnt lgkmcnt(5)
    v_mfma_f32_32x32x16_bf16 v[184:199], v[56:59], v[32:35], v[184:199]
    ds_read_b128 v[232:235], v13 offset:20480
    s_waitcnt lgkmcnt(5)
    v_mfma_f32_32x32x16_bf16 v[184:199], v[60:63], v[36:39], v[184:199]
    ds_read_b128 v[236:239], v13 offset:22528
    s_waitcnt vmcnt(3)
    s_barrier
    s_waitcnt lgkmcnt(5)
    v_mfma_f32_32x32x16_bf16 v[184:199], v[64:67], v[216:219], v[184:199]
    ds_read_b128 v[16:19], v13 offset:24576
    s_waitcnt lgkmcnt(5)
    v_mfma_f32_32x32x16_bf16 v[184:199], v[68:71], v[220:223], v[184:199]
    ds_read_b128 v[20:23], v13 offset:26624
    s_waitcnt lgkmcnt(5)
    v_mfma_f32_32x32x16_bf16 v[184:199], v[72:75], v[224:227], v[184:199]
    ds_read_b128 v[24:27], v13 offset:28672
    s_waitcnt lgkmcnt(5)
    v_mfma_f32_32x32x16_bf16 v[184:199], v[76:79], v[228:231], v[184:199]
    ds_read_b128 v[28:31], v13 offset:30720
    s_waitcnt lgkmcnt(5)
    v_mfma_f32_32x32x16_bf16 v[184:199], v[80:83], v[232:235], v[184:199]
    ds_read_b128 v[32:35], v13 offset:32768
    s_waitcnt lgkmcnt(5)
    v_mfma_f32_32x32x16_bf16 v[184:199], v[84:87], v[236:239], v[184:199]
    ds_read_b128 v[36:39], v13 offset:34816
    s_waitcnt lgkmcnt(5)
    v_mfma_f32_32x32x16_bf16 v[184:199], v[88:91], v[16:19], v[184:199]
    ds_read_b128 v[216:219], v13 offset:36864
    s_waitcnt lgkmcnt(5)
    v_mfma_f32_32x32x16_bf16 v[184:199], v[92:95], v[20:23], v[184:199]
    ds_read_b128 v[220:223], v13 offset:38912
    s_waitcnt lgkmcnt(5)
    v_mfma_f32_32x32x16_bf16 v[184:199], v[96:99], v[24:27], v[184:199]
    ds_read_b128 v[224:227], v13 offset:40960
    s_waitcnt lgkmcnt(5)
    v_mfma_f32_32x32x16_bf16 v[184:199], v[100:103], v[28:31], v[184:199]
    ds_read_b128 v[228:231], v13 offset:43008
    s_waitcnt lgkmcnt(5)
    v_mfma_f32_32x32x16_bf16 v[184:199], v[104:107], v[32:35], v[184:199]
    ds_read_b128 v[232:235], v13 offset:45056
    s_waitcnt lgkmcnt(5)
    v_mfma_f32_32x32x16_bf16 v[184:199], v[108:111], v[36:39], v[184:199]
    ds_read_b128 v[236:239], v13 offset:47104
    s_waitcnt vmcnt(0)
    s_barrier
    s_waitcnt lgkmcnt(5)
    v_mfma_f32_32x32x16_bf16 v[184:199], v[112:115], v[216:219], v[184:199]
    ds_read_b128 v[16:19], v14 offset:0
    s_waitcnt lgkmcnt(5)
    v_mfma_f32_32x32x16_bf16 v[184:199], v[116:119], v[220:223], v[184:199]
    ds_read_b128 v[20:23], v14 offset:2048
    s_waitcnt lgkmcnt(5)
    v_mfma_f32_32x32x16_bf16 v[184:199], v[120:123], v[224:227], v[184:199]
    ds_read_b128 v[24:27], v14 offset:4096
    s_waitcnt lgkmcnt(5)
    v_mfma_f32_32x32x16_bf16 v[184:199], v[124:127], v[228:231], v[184:199]
    ds_read_b128 v[28:31], v14 offset:6144
    s_waitcnt lgkmcnt(5)
    v_mfma_f32_32x32x16_bf16 v[184:199], v[128:131], v[232:235], v[184:199]
    ds_read_b128 v[32:35], v14 offset:8192
    s_waitcnt lgkmcnt(5)
    v_mfma_f32_32x32x16_bf16 v[184:199], v[132:135], v[236:239], v[184:199]
    ds_read_b128 v[36:39], v14 offset:10240
    s_waitcnt lgkmcnt(5)
    v_mfma_f32_32x32x16_bf16 v[184:199], v[136:139], v[16:19], v[184:199]
    ds_read_b128 v[216:219], v14 offset:12288
    s_waitcnt lgkmcnt(5)
    v_mfma_f32_32x32x16_bf16 v[184:199], v[140:143], v[20:23], v[184:199]
    ds_read_b128 v[220:223], v14 offset:14336
    s_waitcnt lgkmcnt(5)
    v_mfma_f32_32x32x16_bf16 v[184:199], v[144:147], v[24:27], v[184:199]
    ds_read2_b32 v[224:225], v201 offset0:0 offset1:32
    ds_read2_b32 v[226:227], v201 offset0:64 offset1:96
    s_waitcnt lgkmcnt(6)
    v_mfma_f32_32x32x16_bf16 v[184:199], v[148:151], v[28:31], v[184:199]
    ds_read2_b32 v[228:229], v202 offset0:0 offset1:32
    ds_read2_b32 v[230:231], v202 offset0:64 offset1:96
    s_waitcnt lgkmcnt(7)
    v_mfma_f32_32x32x16_bf16 v[184:199], v[152:155], v[32:35], v[184:199]
    ds_read2_b32 v[232:233], v203 offset0:0 offset1:32
    ds_read2_b32 v[234:235], v203 offset0:64 offset1:96
    s_waitcnt lgkmcnt(8)
    v_mfma_f32_32x32x16_bf16 v[184:199], v[156:159], v[36:39], v[184:199]
    ds_read2_b32 v[236:237], v204 offset0:0 offset1:32
    ds_read2_b32 v[238:239], v204 offset0:64 offset1:96
    s_waitcnt lgkmcnt(9)
    v_mfma_f32_32x32x16_bf16 v[184:199], v[160:163], v[216:219], v[184:199]
    s_waitcnt lgkmcnt(8)
    v_mfma_f32_32x32x16_bf16 v[184:199], v[164:167], v[220:223], v[184:199]
    s_waitcnt lgkmcnt(6)
    v_mfma_f32_32x32x16_bf16 v[184:199], v[168:171], v[224:227], v[184:199]
    s_waitcnt lgkmcnt(4)
    v_mfma_f32_32x32x16_bf16 v[184:199], v[172:175], v[228:231], v[184:199]
    s_waitcnt lgkmcnt(2)
    v_mfma_f32_32x32x16_bf16 v[184:199], v[176:179], v[232:235], v[184:199]
    s_waitcnt lgkmcnt(0)
    v_mfma_f32_32x32x16_bf16 v[184:199], v[180:183], v[236:239], v[184:199]
    s_nop 11
    v_cvt_pk_bf16_f32 v16, v184, v185
    v_cvt_pk_bf16_f32 v17, v186, v187
    ds_write_b64 v200, v[16:17] offset:0
    v_cvt_pk_bf16_f32 v18, v188, v189
    v_cvt_pk_bf16_f32 v19, v190, v191
    ds_write_b64 v200, v[18:19] offset:16
    v_cvt_pk_bf16_f32 v20, v192, v193
    v_cvt_pk_bf16_f32 v21, v194, v195
    ds_write_b64 v200, v[20:21] offset:32
    v_cvt_pk_bf16_f32 v22, v196, v197
    v_cvt_pk_bf16_f32 v23, v198, v199
    ds_write_b64 v200, v[22:23] offset:48
    s_waitcnt lgkmcnt(0)
    s_barrier
    ds_read_b128 v[16:19], v4
    ds_read_b128 v[20:23], v5
    s_waitcnt lgkmcnt(1)
    buffer_store_dwordx4 v[16:19], v6, s[44:47], s26 offen sc1
    s_waitcnt lgkmcnt(0)
    buffer_store_dwordx4 v[20:23], v7, s[44:47], s26 offen sc1
    s_branch Lfin
Lo_idle:
    s_waitcnt vmcnt(3)
    s_barrier
    s_waitcnt vmcnt(0)
    s_barrier
    s_branch Lfin
Lp3_s3:
    s_sub_u32 s20, s33, 24
    s_lshl_b32 s17, s19, 3
    s_add_u32 s17, s17, s20
    s_mov_b64 s[6:7], s[82:83]
    s_mov_b64 s[48:49], s[86:87]
    s_mov_b64 s[50:51], s[70:71]
    v_min_u32 v17, 15, v0
    v_add_u32 v17, 16, v17
    v_lshlrev_b32 v17, 8, v17
    s_mov_b32 s93, 200000
    s_and_b32 s92, s2, 7
    s_lshl_b32 s92, s92, 15
    s_add_u32 s92, s92, 16523264
    s_mov_b64 exec, 65535
Lp63:
    buffer_load_dword v16, v17, s[12:15], s92 offen sc1
    s_waitcnt vmcnt(0)
    v_cmp_le_u32 vcc, 18, v16
    s_nop 3
    s_cmp_eq_u64 vcc, exec
    s_cbranch_scc1 Ld64
    s_sleep 2
    s_sub_u32 s93, s93, 1
    s_cmp_lg_u32 s93, 0
    s_cbranch_scc1 Lp63
Ld64:
    s_mov_b64 exec, -1
    s_mov_b32 s8, s50
    s_mov_b32 s9, s51
    s_mov_b32 s10, 2359296
    s_mov_b32 s11, 0x20000
    s_mov_b32 s12, s48
    s_mov_b32 s13, s49
    s_mov_b32 s14, 22028288
    s_mov_b32 s15, 0x20000
    s_mov_b32 s44, s6
    s_mov_b32 s45, s7
    s_mov_b32 s46, 4718592
    s_mov_b32 s47, 0x20000
    v_lshrrev_b32 v1, 2, v0
    v_lshlrev_b32 v1, 12, v1
    v_and_b32 v2, 3, v0
    v_lshl_add_u32 v1, v2, 4, v1
    s_lshl_b32 s20, s17, 6
    s_lshl_b32 s21, s16, 16
    s_add_u32 s20, s20, s21
    s_add_u32 s20, s20, 14163968
    s_lshl_b32 s21, s16, 10
    s_mov_b32 s22, s16
Ls3_y:
    s_mov_b32 m0, s21
    s_add_u32 s22, s22, 8
    buffer_load_dwordx4 v1, s[12:15], s20 offen sc1 lds
    s_add_u32 s20, s20, 524288
    s_add_u32 s21, s21, 8192
    s_cmp_lt_u32 s22, 36
    s_cbranch_scc1 Ls3_y
    s_lshl_b32 s22, s16, 6
    v_add_u32 v3, s22, v0
    s_mul_i32 s20, s17, 36864
    s_mul_i32 s23, s17, 73728
    s_add_u32 s23, s23, 1152
    v_add_u32 v4, 0, v3
    v_min_u32 v4, 2303, v4
    v_lshlrev_b32 v5, 4, v4
    buffer_load_dwordx4 v[16:19], v5, s[8:11], s20 offen
    v_mul_u32_u24 v6, 3641, v4
    v_lshrrev_b32 v6, 18, v6
    v_lshl_add_u32 v40, v6, 4, v5
    v_add_u32 v40, 40960, v40
    v_mul_u32_u24 v6, 1152, v6
    v_add_u32 v48, v6, v5
    v_add_u32 v4, 512, v3
    v_min_u32 v4, 2303, v4
    v_lshlrev_b32 v5, 4, v4
    buffer_load_dwordx4 v[20:23], v5, s[8:11], s20 offen
    v_mul_u32_u24 v6, 3641, v4
    v_lshrrev_b32 v6, 18, v6
    v_lshl_add_u32 v41, v6, 4, v5
    v_add_u32 v41, 40960, v41
    v_mul_u32_u24 v6, 1152, v6
    v_add_u32 v49, v6, v5
    v_add_u32 v4, 1024, v3
    v_min_u32 v4, 2303, v4
    v_lshlrev_b32 v5, 4, v4
    buffer_load_dwordx4 v[24:27], v5, s[8:11], s20 offen
    v_mul_u32_u24 v6, 3641, v4
    v_lshrrev_b32 v6, 18, v6
    v_lshl_add_u32 v42, v6, 4, v5
    v_add_u32 v42, 40960, v42
    v_mul_u32_u24 v6, 1152, v6
    v_add_u32 v50, v6, v5
    v_add_u32 v4, 1536, v3
    v_min_u32 v4, 2303, v4
    v_lshlrev_b32 v5, 4, v4
    buffer_load_dwordx4 v[28:31], v5, s[8:11], s20 offen
    v_mul_u32_u24 v6, 3641, v4
    v_lshrrev_b32 v6, 18, v6
    v_lshl_add_u32 v43, v6, 4, v5
    v_add_u32 v43, 40960, v43
    v_mul_u32_u24 v6, 1152, v6
    v_add_u32 v51, v6, v5
    v_add_u32 v4, 2048, v3
    v_min_u32 v4, 2303, v4
    v_lshlrev_b32 v5, 4, v4
    buffer_load_dwordx4 v[32:35], v5, s[8:11], s20 offen
    v_mul_u32_u24 v6, 3641, v4
    v_lshrrev_b32 v6, 18, v6
    v_lshl_add_u32 v44, v6, 4, v5
    v_add_u32 v44, 40960, v44
    v_mul_u32_u24 v6, 1152, v6
    v_add_u32 v52, v6, v5
    v_bfe_u32 v4, v0, 2, 2
    v_lshrrev_b32 v5, 5, v0
    v_lshl_add_u32 v4, v5, 3, v4
    v_lshlrev_b32 v4, 6, v4
    v_bfe_u32 v6, v0, 4, 1
    v_lshl_add_u32 v4, v6, 5, v4
    v_and_b32 v6, 3, v0
    v_lshl_add_u32 v4, v6, 3, v4
    s_lshl_b32 s21, s16, 10
    v_add_u32 v4, s21, v4
    v_and_b32 v6, 31, v0
    v_mul_u32_u24 v6, 1168, v6
    v_lshl_add_u32 v6, v5, 4, v6
    s_lshl_b32 s21, s16, 5
    s_add_u32 s21, s21, 40960
    v_add_u32 v6, s21, v6
    s_waitcnt vmcnt(5)
    ds_read_b64_tr_b16 v[56:57], v4 offset:0
    ds_read_b64_tr_b16 v[58:59], v4 offset:256
    s_waitcnt lgkmcnt(0)
    ds_write_b128 v6, v[56:59] offset:0
    ds_read_b64_tr_b16 v[56:57], v4 offset:8192
    ds_read_b64_tr_b16 v[58:59], v4 offset:8448
    s_waitcnt lgkmcnt(0)
    ds_write_b128 v6, v[56:59] offset:256
    ds_read_b64_tr_b16 v[56:57], v4 offset:16384
    ds_read_b64_tr_b16 v[58:59], v4 offset:16640
    s_waitcnt lgkmcnt(0)
    ds_write_b128 v6, v[56:59] offset:512
    ds_read_b64_tr_b16 v[56:57], v4 offset:24576
    ds_read_b64_tr_b16 v[58:59], v4 offset:24832
    s_waitcnt lgkmcnt(0)
    ds_write_b128 v6, v[56:59] offset:768
    s_cmp_ge_u32 s16, 4
    s_cbranch_scc1 Ls3_t4
    ds_read_b64_tr_b16 v[56:57], v4 offset:32768
    ds_read_b64_tr_b16 v[58:59], v4 offset:33024
    s_waitcnt lgkmcnt(0)
    ds_write_b128 v6, v[56:59] offset:1024
Ls3_t4:
    s_waitcnt vmcnt(0) lgkmcnt(0)
    s_barrier
    ds_read_b128 v[60:63], v40
    ds_read_b128 v[64:67], v41
    ds_read_b128 v[68:71], v42
    ds_read_b128 v[72:75], v43
    ds_read_b128 v[76:79], v44
    s_waitcnt lgkmcnt(4)
    v_lshlrev_b32 v8, 16, v60
    v_lshlrev_b32 v9, 16, v16
    v_and_b32 v60, 0xffff0000, v60
    v_and_b32 v16, 0xffff0000, v16
    v_mul_f32 v8, v8, v9
    v_mul_f32 v9, v60, v16
    v_cvt_pk_bf16_f32 v60, v8, v9
    v_lshlrev_b32 v8, 16, v61
    v_lshlrev_b32 v9, 16, v17
    v_and_b32 v61, 0xffff0000, v61
    v_and_b32 v17, 0xffff0000, v17
    v_mul_f32 v8, v8, v9
    v_mul_f32 v9, v61, v17
    v_cvt_pk_bf16_f32 v61, v8, v9
    v_lshlrev_b32 v8, 16, v62
    v_lshlrev_b32 v9, 16, v18
    v_and_b32 v62, 0xffff0000, v62
    v_and_b32 v18, 0xffff0000, v18
    v_mul_f32 v8, v8, v9
    v_mul_f32 v9, v62, v18
    v_cvt_pk_bf16_f32 v62, v8, v9
    v_lshlrev_b32 v8, 16, v63
    v_lshlrev_b32 v9, 16, v19
    v_and_b32 v63, 0xffff0000, v63
    v_and_b32 v19, 0xffff0000, v19
    v_mul_f32 v8, v8, v9
    v_mul_f32 v9, v63, v19
    v_cvt_pk_bf16_f32 v63, v8, v9
    buffer_store_dwordx4 v[60:63], v48, s[44:47], s23 offen sc1
    s_waitcnt lgkmcnt(3)
    v_lshlrev_b32 v8, 16, v64
    v_lshlrev_b32 v9, 16, v20
    v_and_b32 v64, 0xffff0000, v64
    v_and_b32 v20, 0xffff0000, v20
    v_mul_f32 v8, v8, v9
    v_mul_f32 v9, v64, v20
    v_cvt_pk_bf16_f32 v64, v8, v9
    v_lshlrev_b32 v8, 16, v65
    v_lshlrev_b32 v9, 16, v21
    v_and_b32 v65, 0xffff0000, v65
    v_and_b32 v21, 0xffff0000, v21
    v_mul_f32 v8, v8, v9
    v_mul_f32 v9, v65, v21
    v_cvt_pk_bf16_f32 v65, v8, v9
    v_lshlrev_b32 v8, 16, v66
    v_lshlrev_b32 v9, 16, v22
    v_and_b32 v66, 0xffff0000, v66
    v_and_b32 v22, 0xffff0000, v22
    v_mul_f32 v8, v8, v9
    v_mul_f32 v9, v66, v22
    v_cvt_pk_bf16_f32 v66, v8, v9
    v_lshlrev_b32 v8, 16, v67
    v_lshlrev_b32 v9, 16, v23
    v_and_b32 v67, 0xffff0000, v67
    v_and_b32 v23, 0xffff0000, v23
    v_mul_f32 v8, v8, v9
    v_mul_f32 v9, v67, v23
    v_cvt_pk_bf16_f32 v67, v8, v9
    buffer_store_dwordx4 v[64:67], v49, s[44:47], s23 offen sc1
    s_waitcnt lgkmcnt(2)
    v_lshlrev_b32 v8, 16, v68
    v_lshlrev_b32 v9, 16, v24
    v_and_b32 v68, 0xffff0000, v68
    v_and_b32 v24, 0xffff0000, v24
    v_mul_f32 v8, v8, v9
    v_mul_f32 v9, v68, v24
    v_cvt_pk_bf16_f32 v68, v8, v9
    v_lshlrev_b32 v8, 16, v69
    v_lshlrev_b32 v9, 16, v25
    v_and_b32 v69, 0xffff0000, v69
    v_and_b32 v25, 0xffff0000, v25
    v_mul_f32 v8, v8, v9
    v_mul_f32 v9, v69, v25
    v_cvt_pk_bf16_f32 v69, v8, v9
    v_lshlrev_b32 v8, 16, v70
    v_lshlrev_b32 v9, 16, v26
    v_and_b32 v70, 0xffff0000, v70
    v_and_b32 v26, 0xffff0000, v26
    v_mul_f32 v8, v8, v9
    v_mul_f32 v9, v70, v26
    v_cvt_pk_bf16_f32 v70, v8, v9
    v_lshlrev_b32 v8, 16, v71
    v_lshlrev_b32 v9, 16, v27
    v_and_b32 v71, 0xffff0000, v71
    v_and_b32 v27, 0xffff0000, v27
    v_mul_f32 v8, v8, v9
    v_mul_f32 v9, v71, v27
    v_cvt_pk_bf16_f32 v71, v8, v9
    buffer_store_dwordx4 v[68:71], v50, s[44:47], s23 offen sc1
    s_waitcnt lgkmcnt(1)
    v_lshlrev_b32 v8, 16, v72
    v_lshlrev_b32 v9, 16, v28
    v_and_b32 v72, 0xffff0000, v72
    v_and_b32 v28, 0xffff0000, v28
    v_mul_f32 v8, v8, v9
    v_mul_f32 v9, v72, v28
    v_cvt_pk_bf16_f32 v72, v8, v9
    v_lshlrev_b32 v8, 16, v73
    v_lshlrev_b32 v9, 16, v29
    v_and_b32 v73, 0xffff0000, v73
    v_and_b32 v29, 0xffff0000, v29
    v_mul_f32 v8, v8, v9
    v_mul_f32 v9, v73, v29
    v_cvt_pk_bf16_f32 v73, v8, v9
    v_lshlrev_b32 v8, 16, v74
    v_lshlrev_b32 v9, 16, v30
    v_and_b32 v74, 0xffff0000, v74
    v_and_b32 v30, 0xffff0000, v30
    v_mul_f32 v8, v8, v9
    v_mul_f32 v9, v74, v30
    v_cvt_pk_bf16_f32 v74, v8, v9
    v_lshlrev_b32 v8, 16, v75
    v_lshlrev_b32 v9, 16, v31
    v_and_b32 v75, 0xffff0000, v75
    v_and_b32 v31, 0xffff0000, v31
    v_mul_f32 v8, v8, v9
    v_mul_f32 v9, v75, v31
    v_cvt_pk_bf16_f32 v75, v8, v9
    buffer_store_dwordx4 v[72:75], v51, s[44:47], s23 offen sc1
    s_waitcnt lgkmcnt(0)
    v_lshlrev_b32 v8, 16, v76
    v_lshlrev_b32 v9, 16, v32
    v_and_b32 v76, 0xffff0000, v76
    v_and_b32 v32, 0xffff0000, v32
    v_mul_f32 v8, v8, v9
    v_mul_f32 v9, v76, v32
    v_cvt_pk_bf16_f32 v76, v8, v9
    v_lshlrev_b32 v8, 16, v77
    v_lshlrev_b32 v9, 16, v33
    v_and_b32 v77, 0xffff0000, v77
    v_and_b32 v33, 0xffff0000, v33
    v_mul_f32 v8, v8, v9
    v_mul_f32 v9, v77, v33
    v_cvt_pk_bf16_f32 v77, v8, v9
    v_lshlrev_b32 v8, 16, v78
    v_lshlrev_b32 v9, 16, v34
    v_and_b32 v78, 0xffff0000, v78
    v_and_b32 v34, 0xffff0000, v34
    v_mul_f32 v8, v8, v9
    v_mul_f32 v9, v78, v34
    v_cvt_pk_bf16_f32 v78, v8, v9
    v_lshlrev_b32 v8, 16, v79
    v_lshlrev_b32 v9, 16, v35
    v_and_b32 v79, 0xffff0000, v79
    v_and_b32 v35, 0xffff0000, v35
    v_mul_f32 v8, v8, v9
    v_mul_f32 v9, v79, v35
    v_cvt_pk_bf16_f32 v79, v8, v9
    buffer_store_dwordx4 v[76:79], v52, s[44:47], s23 offen sc1
Lfin:
    s_endpgm
Lend:
    s_endpgm
Lcode_end:
.section .rodata,"a"
.p2align 6
.amdhsa_kernel concat_heads__softmax_full_mha__ssm_conv_h3__prompt_kernel
  .amdhsa_next_free_vgpr 248
  .amdhsa_next_free_sgpr 102
  .amdhsa_accum_offset 248
  .amdhsa_group_segment_fixed_size 0
  .amdhsa_kernarg_size 96
  .amdhsa_user_sgpr_count 2
  .amdhsa_user_sgpr_kernarg_segment_ptr 1
  .amdhsa_system_sgpr_workgroup_id_x 1
.end_amdhsa_kernel
```
